```python
import torch

def _softmax(x, axis=-1):
    return torch.softmax(x, dim=axis)
def _gelu(x):
    return torch.nn.functional.gelu(x, approximate="tanh")
def _silu(x):
    return torch.nn.functional.silu(x)
def _sigmoid(x):
    return torch.sigmoid(x)
def _layernorm(x, axis=-1, eps=1e-5):
    m = x.mean(dim=axis, keepdim=True)
    v = x.var(dim=axis, keepdim=True, unbiased=False)
    return (x - m) / torch.sqrt(v + eps)
def _scatter_add(tgt, idx, src, axis=0):
    return tgt.clone().index_add_(axis, idx, src)
def _segment_sum(src, seg, n):
    out = torch.zeros((n,) + src.shape[1:], dtype=src.dtype)
    return out.index_add_(0, seg, src)
def _pad(x, pw):
    flat = tuple(v for pair in reversed(pw) for v in pair)
    return torch.nn.functional.pad(x, flat)

kernel_name = 'concat_heads__gqa_block_cached__gqa_block_cached__near_ridge'

def setup_inputs():

    _w = (lambda a: (lambda t: t.to(torch.bfloat16) if t.is_floating_point() else t)(torch.as_tensor(a)))
    def _A_setup():
        B, Sq, D = 16, 144, 640
        Hq, Hkv, Sk, Dh = 32, 32, 512, 128
        assert Hq % Hkv == 0, (Hq, Hkv)
        return {
            "x": _w((lambda *s: torch.randn(*s, dtype=torch.bfloat16) * 0.8)(B, Sq, D)),
            "k_cache": _w((lambda *s: torch.randn(*s, dtype=torch.bfloat16) * 0.8)(B, Hkv, Sk, Dh)),
            "v_cache": _w((lambda *s: torch.randn(*s, dtype=torch.bfloat16) * 0.05)(B, Hkv, Sk, Dh)),
            "wq": _w((lambda *s: torch.randn(*s, dtype=torch.bfloat16) * 0.8)(D, Hq * Dh) * (D ** -0.5)),
            "wo": _w((lambda *s: torch.randn(*s, dtype=torch.bfloat16) * 0.05)(Hq * Dh, D) * ((Hq * Dh) ** -0.5)),
        }
    _A_in = _A_setup()

    def _B_setup():
        B, Sq, D = 16, 144, 640
        Hq, Hkv, Sk, Dh = 32, 32, 512, 128
        assert Hq % Hkv == 0, (Hq, Hkv)
        return {
            "x": _w((lambda *s: torch.randn(*s, dtype=torch.bfloat16) * 0.8)(B, Sq, D)),
            "k_cache": _w((lambda *s: torch.randn(*s, dtype=torch.bfloat16) * 0.8)(B, Hkv, Sk, Dh)),
            "v_cache": _w((lambda *s: torch.randn(*s, dtype=torch.bfloat16) * 0.05)(B, Hkv, Sk, Dh)),
            "wq": _w((lambda *s: torch.randn(*s, dtype=torch.bfloat16) * 0.8)(D, Hq * Dh) * (D ** -0.5)),
            "wo": _w((lambda *s: torch.randn(*s, dtype=torch.bfloat16) * 0.05)(Hq * Dh, D) * ((Hq * Dh) ** -0.5)),
        }
    _B_in = _B_setup()

    return {
        "A_x": _A_in["x"],
        "A_k_cache": _A_in["k_cache"],
        "A_v_cache": _A_in["v_cache"],
        "A_wq": _A_in["wq"],
        "A_wo": _A_in["wo"],
        "B_x": _B_in["x"],
        "B_k_cache": _B_in["k_cache"],
        "B_v_cache": _B_in["v_cache"],
        "B_wq": _B_in["wq"],
        "B_wo": _B_in["wo"],
    }

def reference(A_x, A_k_cache, A_v_cache, A_wq, A_wo, B_x, B_k_cache, B_v_cache, B_wq, B_wo):
    def _A_ref(x, k_cache, v_cache, wq, wo):
        B, Sq, D = x.shape
        Hq, Dh = 32, 128
        Hkv = k_cache.shape[1]
        rep = Hq // Hkv
        q = (lambda x, *d: x.permute(*d))((x @ wq).reshape(B, Sq, Hq, Dh), 0, 2, 1, 3)
        k = (lambda x, n, axis: torch.repeat_interleave(x, n, dim=axis))(k_cache, rep, axis=1)
        v = (lambda x, n, axis: torch.repeat_interleave(x, n, dim=axis))(v_cache, rep, axis=1)
        scores = torch.einsum("bhqd,bhkd->bhqk", q, k) * (Dh ** -0.5)
        p = _softmax(scores, axis=-1)
        o = torch.einsum("bhqk,bhkd->bhqd", p, v)
        return (lambda x, *d: x.permute(*d))(o, 0, 2, 1, 3).reshape(B, Sq, Hq * Dh) @ wo

    def _B_ref(x, k_cache, v_cache, wq, wo):
        B, Sq, D = x.shape
        Hq, Dh = 32, 128
        Hkv = k_cache.shape[1]
        rep = Hq // Hkv
        q = (lambda x, *d: x.permute(*d))((x @ wq).reshape(B, Sq, Hq, Dh), 0, 2, 1, 3)
        k = (lambda x, n, axis: torch.repeat_interleave(x, n, dim=axis))(k_cache, rep, axis=1)
        v = (lambda x, n, axis: torch.repeat_interleave(x, n, dim=axis))(v_cache, rep, axis=1)
        scores = torch.einsum("bhqd,bhkd->bhqk", q, k) * (Dh ** -0.5)
        p = _softmax(scores, axis=-1)
        o = torch.einsum("bhqk,bhkd->bhqd", p, v)
        return (lambda x, *d: x.permute(*d))(o, 0, 2, 1, 3).reshape(B, Sq, Hq * Dh) @ wo

    a = _A_ref(A_x, A_k_cache, A_v_cache, A_wq, A_wo)
    b = _B_ref(B_x, B_k_cache, B_v_cache, B_wq, B_wo)
    return torch.concatenate([a, b], axis=-1)
```

```asm
; @launch kernel=concat_heads__gqa_block_cached__gqa_block_cached__near_ridge_kernel grid=(512,1,1) block=(256,1,1) lds=73728
; @launch kernel=oproj_kernel grid=(256,1,1) block=(256,1,1) lds=98304
.amdgcn_target "amdgcn-amd-amdhsa--gfx950"
.text
.globl concat_heads__gqa_block_cached__gqa_block_cached__near_ridge_kernel
.p2align 8
.type concat_heads__gqa_block_cached__gqa_block_cached__near_ridge_kernel,@function
concat_heads__gqa_block_cached__gqa_block_cached__near_ridge_kernel:
    s_cmp_ge_u32 s2, 512
    s_cbranch_scc1 L_k1_end
    s_load_dwordx16 s[16:31], s[0:1], 0
    s_load_dwordx8 s[32:39], s[0:1], 64
    s_load_dwordx2 s[40:41], s[0:1], 96
    v_lshrrev_b32 v246, 6, v0
    v_and_b32 v247, 63, v0
    s_nop 0
    v_readfirstlane_b32 s3, v246
    s_and_b32 s8, s2, 7
    s_lshr_b32 s9, s2, 3
    s_lshr_b32 s4, s8, 2
    s_lshr_b32 s5, s9, 2
    s_and_b32 s6, s8, 3
    s_lshl_b32 s6, s6, 2
    s_and_b32 s10, s9, 3
    s_add_u32 s6, s6, s10
    s_lshl_b32 s7, s5, 4
    s_add_u32 s7, s7, s6
    s_lshl_b32 s7, s7, 18
    s_mov_b32 s42, s7
    s_mov_b32 s7, 0
    s_mov_b32 s8, 0
    s_lshr_b32 s72, s2, 3
    s_add_u32 s72, s72, s2
    s_and_b32 s72, s72, 7
    s_lshl_b32 s72, s72, 14
    s_lshl_b32 s43, s4, 4
    s_add_u32 s43, s43, s5
    s_lshl_b32 s43, s43, 4
    s_add_u32 s43, s43, s6
    s_mul_i32 s43, s43, 73728
    s_lshl_b32 s9, s3, 10
    s_mov_b32 s11, 0x3e0293ee
    s_mov_b32 s12, 0x41000000
    v_lshrrev_b32 v248, 4, v247
    v_and_b32 v249, 15, v247
    v_lshlrev_b32 v255, 4, v247
    s_lshl_b32 s10, s3, 2
    v_add_u32 v250, s10, v248
    v_xor_b32 v251, v249, v250
    v_lshlrev_b32 v251, 4, v251
    v_lshl_add_u32 v237, v250, 8, v251
    v_lshlrev_b32 v251, 2, v248
    v_xor_b32 v251, v249, v251
    v_lshlrev_b32 v251, 4, v251
    v_lshl_add_u32 v238, v250, 8, v251
    v_lshl_add_u32 v239, v250, 13, v251
    s_lshl_b32 s73, s6, 9
    s_mul_i32 s10, s5, 144
    s_lshl_b32 s14, s3, 5
    s_add_u32 s14, s14, s10
    s_movk_i32 s15, 1280
    v_lshrrev_b32 v250, 2, v247
    v_add_u32 v251, s14, v250
    v_mul_lo_u32 v251, v251, s15
    v_lshrrev_b32 v252, 5, v247
    v_xor_b32 v253, v252, v247
    v_and_b32 v253, 3, v253
    v_lshl_add_u32 v240, v253, 4, v251
    v_xor_b32 v212, 32, v240
    v_add_u32 v212, 0x5000, v212
    s_sub_u32 s14, 4, s3
    v_xor_b32 v253, s14, v247
    v_and_b32 v253, 3, v253
    s_lshl_b32 s14, s3, 2
    s_add_u32 s14, s14, s10
    s_add_u32 s14, s14, 128
    v_and_b32 v250, 3, v250
    v_add_u32 v251, s14, v250
    v_mul_lo_u32 v251, v251, s15
    v_lshl_add_u32 v241, v253, 4, v251
    v_and_b32 v250, 31, v247
    v_lshrrev_b32 v251, 3, v250
    v_xor_b32 v251, v251, v252
    v_lshlrev_b32 v251, 4, v251
    v_lshl_add_u32 v213, v250, 6, v251
    s_lshl_b32 s14, s3, 11
    s_add_u32 s76, s14, 8192
    v_add_u32 v213, s76, v213
    v_lshrrev_b32 v250, 2, v249
    v_sub_u32 v251, 4, v250
    v_xor_b32 v251, v251, v248
    v_and_b32 v251, 3, v251
    v_lshlrev_b32 v251, 4, v251
    v_lshl_add_u32 v214, v249, 6, v251
    v_add_u32 v214, 0x11000, v214
    s_lshl_b32 s77, s3, 8
    s_add_u32 s77, s77, 0x11000
    s_lshr_b32 s78, s2, 8
    s_and_b32 s78, s78, 0
    s_lshl_b32 s10, s78, 8
    s_add_u32 s74, s73, s10
    s_mov_b32 s75, 0
    s_xor_b32 s10, s10, 256
    s_add_u32 s73, s73, s10
    s_mov_b32 s79, s78
    v_lshrrev_b32 v252, 5, v247
    s_movk_i32 s13, 0x2800
    v_mul_lo_u32 v250, v248, s13
    v_lshl_add_u32 v250, v249, 1, v250
    s_waitcnt lgkmcnt(0)
    s_cmp_eq_u32 s4, 0
    s_cselect_b32 s16, s16, s26
    s_cselect_b32 s17, s17, s27
    s_cselect_b32 s18, s18, s28
    s_cselect_b32 s19, s19, s29
    s_cselect_b32 s20, s20, s30
    s_cselect_b32 s21, s21, s31
    s_cselect_b32 s22, s22, s32
    s_cselect_b32 s23, s23, s33
    s_cselect_b32 s24, s24, s34
    s_cselect_b32 s25, s25, s35
    s_mov_b32 s48, s18
    s_and_b32 s49, s19, 0xffff
    s_mov_b32 s50, 0x4000000
    s_mov_b32 s51, 0x20000
    s_mov_b32 s52, s20
    s_and_b32 s53, s21, 0xffff
    s_mov_b32 s54, 0x4000000
    s_mov_b32 s55, 0x20000
    s_mov_b32 s60, s24
    s_and_b32 s61, s25, 0xffff
    s_mov_b32 s62, 0x500000
    s_mov_b32 s63, 0x20000
    s_mov_b32 s44, s16
    s_and_b32 s45, s17, 0xffff
    s_mov_b32 s46, 0x2d0000
    s_mov_b32 s47, 0x20000
    s_mov_b32 s56, s22
    s_and_b32 s57, s23, 0xffff
    s_mov_b32 s58, 0x500000
    s_mov_b32 s59, 0x20000
    s_mov_b32 s64, s40
    s_and_b32 s65, s41, 0xffff
    s_mov_b32 s66, 0x2400000
    s_mov_b32 s67, 0x20000
    s_add_u32 s40, s40, 0x2400000
    s_addc_u32 s41, s41, 0
    s_mov_b32 s68, s40
    s_and_b32 s69, s41, 0xffff
    s_mov_b32 s70, 0xa00000
    s_mov_b32 s71, 0x20000
    s_add_u32 s40, s40, 0xa00000
    s_addc_u32 s41, s41, 0
    s_mov_b32 s80, s40
    s_and_b32 s81, s41, 0xffff
    s_mov_b32 s82, 0x2400000
    s_mov_b32 s83, 0x20000
    s_mul_i32 s84, s2, 49152
    s_mul_i32 s10, s3, 12288
    s_add_u32 s84, s84, s10
    s_add_u32 s85, s84, 4096
    s_add_u32 s86, s84, 8192
    s_add_u32 m0, s9, 0x0
    s_add_u32 s10, s74, 0x0
    buffer_load_dwordx4 v239, s[56:59], s10 offen lds
    s_add_u32 m0, s9, 0x1000
    s_add_u32 s10, s74, 0x20000
    buffer_load_dwordx4 v239, s[56:59], s10 offen lds
    s_add_u32 m0, s76, 0x0
    s_add_u32 s74, s74, 0x40000
    buffer_load_dwordx4 v240, s[44:47], s75 offen lds
    s_add_u32 m0, s76, 0x400
    s_nop 0
    buffer_load_dwordx4 v212, s[44:47], s75 offen lds
    s_add_u32 m0, s77, 0x0
    s_mov_b64 exec, 0xffff
    buffer_load_dwordx4 v241, s[44:47], s75 offen lds
    s_mov_b64 exec, -1
    s_add_u32 s75, s75, 64
    s_add_u32 m0, s9, 0x4000
    s_add_u32 s10, s74, 0x0
    buffer_load_dwordx4 v239, s[56:59], s10 offen lds
    s_add_u32 m0, s9, 0x5000
    s_add_u32 s10, s74, 0x20000
    buffer_load_dwordx4 v239, s[56:59], s10 offen lds
    s_add_u32 m0, s76, 0x4000
    s_add_u32 s74, s74, 0x40000
    buffer_load_dwordx4 v240, s[44:47], s75 offen lds
    s_add_u32 m0, s76, 0x4400
    s_nop 0
    buffer_load_dwordx4 v212, s[44:47], s75 offen lds
    s_add_u32 m0, s77, 0x400
    s_mov_b64 exec, 0xffff
    buffer_load_dwordx4 v241, s[44:47], s75 offen lds
    s_mov_b64 exec, -1
    s_add_u32 s75, s75, 64
    s_add_u32 m0, s9, 0x8000
    s_add_u32 s10, s74, 0x0
    buffer_load_dwordx4 v239, s[56:59], s10 offen lds
    s_add_u32 m0, s9, 0x9000
    s_add_u32 s10, s74, 0x20000
    buffer_load_dwordx4 v239, s[56:59], s10 offen lds
    s_add_u32 m0, s76, 0x8000
    s_add_u32 s74, s74, 0x40000
    buffer_load_dwordx4 v240, s[44:47], s75 offen lds
    s_add_u32 m0, s76, 0x8400
    s_nop 0
    buffer_load_dwordx4 v212, s[44:47], s75 offen lds
    s_add_u32 m0, s77, 0x800
    s_mov_b64 exec, 0xffff
    buffer_load_dwordx4 v241, s[44:47], s75 offen lds
    s_mov_b64 exec, -1
    s_add_u32 s75, s75, 64
    s_and_b32 s14, s5, 7
    s_lshl_b32 s15, s6, 3
    s_add_u32 s14, s14, s15
    s_lshr_b32 s15, s5, 3
    s_lshl_b32 s15, s15, 2
    s_add_u32 s15, s15, s3
    s_mul_i32 s17, s14, 40960
    s_mul_i32 s18, s15, 160
    s_add_u32 s17, s17, s18
    s_add_u32 s18, s17, 2560
    s_add_u32 s19, s17, 5120
    s_add_u32 s20, s17, 7680
    v_mov_b32 v184, v250
    s_lshl_b32 s22, s4, 3
    s_add_u32 s21, s15, s22
    s_lshl_b32 s21, s21, 7
    s_add_u32 s21, s21, s14
    s_mul_i32 s23, s21, 5120
    s_add_u32 s24, s23, 4096
    v_and_b32 v250, 31, v247
    v_and_b32 v251, 19, v250
    v_and_b32 v253, 4, v250
    v_lshl_add_u32 v251, v253, 1, v251
    v_and_b32 v253, 8, v250
    v_lshrrev_b32 v253, 1, v253
    v_add_u32 v251, v251, v253
    v_and_b32 v253, 15, v251
    v_xor_b32 v253, v253, v252
    v_lshlrev_b32 v253, 4, v253
    v_lshl_add_u32 v222, v251, 8, v253
    v_xor_b32 v223, 32, v222
    v_xor_b32 v224, 64, v222
    v_xor_b32 v225, 96, v222
    v_xor_b32 v226, 128, v222
    v_xor_b32 v227, 160, v222
    v_xor_b32 v228, 192, v222
    v_xor_b32 v229, 224, v222
    v_lshrrev_b32 v250, 2, v249
    v_and_b32 v251, 3, v249
    v_and_b32 v253, 1, v248
    v_and_b32 v254, 1, v251
    v_lshl_add_u32 v253, v253, 1, v254
    v_lshl_add_u32 v253, v250, 2, v253
    v_lshlrev_b32 v253, 4, v253
    v_lshrrev_b32 v254, 1, v251
    v_lshl_add_u32 v253, v254, 3, v253
    v_lshl_add_u32 v254, v252, 3, v250
    v_lshl_add_u32 v230, v254, 8, v253
    v_xor_b32 v231, 64, v230
    v_xor_b32 v232, 128, v230
    v_xor_b32 v233, 192, v230
    s_lshl_b32 s10, s3, 4
    v_add_u32 v253, s10, v249
    v_xor_b32 v254, v248, v249
    v_lshlrev_b32 v254, 4, v254
    v_lshl_add_u32 v234, v253, 8, v254
    v_lshl_add_u32 v253, v248, 2, v250
    v_add_u32 v253, s10, v253
    v_lshl_add_u32 v254, v250, 2, v251
    v_lshlrev_b32 v254, 4, v254
    v_lshl_add_u32 v235, v253, 8, v254
    s_lshl_b32 s10, s3, 6
    v_xor_b32 v254, s10, v254
    v_lshl_add_u32 v253, v248, 3, v250
    v_lshl_add_u32 v215, v253, 8, v254
    v_lshl_add_u32 v253, v252, 4, v249
    v_lshlrev_b32 v253, 4, v253
    v_and_b32 v254, 1, v248
    v_lshl_add_u32 v236, v254, 10, v253
    s_mov_b32 s28, 0
L_k1_head:
    s_mov_b32 s91, s28
    s_nop 1
    v_mov_b32 v0, 0
    v_mov_b32 v1, 0
    v_mov_b32 v2, 0
    v_mov_b32 v3, 0
    v_mov_b32 v4, 0
    v_mov_b32 v5, 0
    v_mov_b32 v6, 0
    v_mov_b32 v7, 0
    v_mov_b32 v8, 0
    v_mov_b32 v9, 0
    v_mov_b32 v10, 0
    v_mov_b32 v11, 0
    v_mov_b32 v12, 0
    v_mov_b32 v13, 0
    v_mov_b32 v14, 0
    v_mov_b32 v15, 0
    v_mov_b32 v16, 0
    v_mov_b32 v17, 0
    v_mov_b32 v18, 0
    v_mov_b32 v19, 0
    v_mov_b32 v20, 0
    v_mov_b32 v21, 0
    v_mov_b32 v22, 0
    v_mov_b32 v23, 0
    v_mov_b32 v24, 0
    v_mov_b32 v25, 0
    v_mov_b32 v26, 0
    v_mov_b32 v27, 0
    v_mov_b32 v28, 0
    v_mov_b32 v29, 0
    v_mov_b32 v30, 0
    v_mov_b32 v31, 0
    v_mov_b32 v32, 0
    v_mov_b32 v33, 0
    v_mov_b32 v34, 0
    v_mov_b32 v35, 0
    v_mov_b32 v36, 0
    v_mov_b32 v37, 0
    v_mov_b32 v38, 0
    v_mov_b32 v39, 0
    v_mov_b32 v40, 0
    v_mov_b32 v41, 0
    v_mov_b32 v42, 0
    v_mov_b32 v43, 0
    v_mov_b32 v44, 0
    v_mov_b32 v45, 0
    v_mov_b32 v46, 0
    v_mov_b32 v47, 0
    v_mov_b32 v48, 0
    v_mov_b32 v49, 0
    v_mov_b32 v50, 0
    v_mov_b32 v51, 0
    v_mov_b32 v52, 0
    v_mov_b32 v53, 0
    v_mov_b32 v54, 0
    v_mov_b32 v55, 0
    v_mov_b32 v56, 0
    v_mov_b32 v57, 0
    v_mov_b32 v58, 0
    v_mov_b32 v59, 0
    v_mov_b32 v60, 0
    v_mov_b32 v61, 0
    v_mov_b32 v62, 0
    v_mov_b32 v63, 0
    v_mov_b32 v64, 0
    v_mov_b32 v65, 0
    v_mov_b32 v66, 0
    v_mov_b32 v67, 0
    v_mov_b32 v68, 0
    v_mov_b32 v69, 0
    v_mov_b32 v70, 0
    v_mov_b32 v71, 0
    v_xor_b32 v247, 32, v213
    s_mov_b32 s27, 0
L_k1_qp:
    s_cmp_eq_u32 s91, 1
    s_cbranch_scc1 L_k1_lax0
    s_waitcnt vmcnt(10)
L_k1_lax0:
    s_waitcnt vmcnt(20)
    s_barrier
    ds_read_b128 v[96:99], v213 offset:0
    ds_read_b128 v[100:103], v247 offset:0
    ds_read_b128 v[104:107], v214 offset:0
    s_add_u32 m0, s9, 0xc000
    s_add_u32 s10, s74, 0x0
    buffer_load_dwordx4 v239, s[56:59], s10 offen lds
    s_add_u32 m0, s9, 0xd000
    s_add_u32 s10, s74, 0x20000
    buffer_load_dwordx4 v239, s[56:59], s10 offen lds
    s_add_u32 m0, s76, 0xc000
    s_add_u32 s74, s74, 0x40000
    buffer_load_dwordx4 v240, s[44:47], s75 offen lds
    s_add_u32 m0, s76, 0xc400
    s_nop 0
    buffer_load_dwordx4 v212, s[44:47], s75 offen lds
    s_add_u32 m0, s77, 0xc00
    s_mov_b64 exec, 0xffff
    buffer_load_dwordx4 v241, s[44:47], s75 offen lds
    s_mov_b64 exec, -1
    s_add_u32 s75, s75, 64
    ds_read_b64_tr_b16 v[192:193], v230 offset:0
    ds_read_b64_tr_b16 v[194:195], v230 offset:1024
    ds_read_b64_tr_b16 v[196:197], v231 offset:0
    ds_read_b64_tr_b16 v[198:199], v231 offset:1024
    ds_read_b64_tr_b16 v[200:201], v232 offset:0
    ds_read_b64_tr_b16 v[202:203], v232 offset:1024
    ds_read_b64_tr_b16 v[204:205], v233 offset:0
    ds_read_b64_tr_b16 v[206:207], v233 offset:1024
    s_waitcnt lgkmcnt(6)
    v_mfma_f32_32x32x16_bf16 v[0:15], v[192:195], v[96:99], v[0:15]
    ds_read_b64_tr_b16 v[208:209], v230 offset:4096
    ds_read_b64_tr_b16 v[210:211], v230 offset:5120
    s_waitcnt lgkmcnt(6)
    v_mfma_f32_32x32x16_bf16 v[16:31], v[196:199], v[96:99], v[16:31]
    ds_read_b64_tr_b16 v[192:193], v231 offset:4096
    ds_read_b64_tr_b16 v[194:195], v231 offset:5120
    s_waitcnt lgkmcnt(6)
    v_mfma_f32_32x32x16_bf16 v[32:47], v[200:203], v[96:99], v[32:47]
    ds_read_b64_tr_b16 v[196:197], v232 offset:4096
    ds_read_b64_tr_b16 v[198:199], v232 offset:5120
    s_waitcnt lgkmcnt(6)
    v_mfma_f32_32x32x16_bf16 v[48:63], v[204:207], v[96:99], v[48:63]
    ds_read_b64_tr_b16 v[200:201], v233 offset:4096
    ds_read_b64_tr_b16 v[202:203], v233 offset:5120
    s_waitcnt lgkmcnt(6)
    v_mfma_f32_32x32x16_bf16 v[0:15], v[208:211], v[100:103], v[0:15]
    ds_read_b64_tr_b16 v[204:205], v215 offset:0
    ds_read_b64_tr_b16 v[206:207], v215 offset:1024
    s_waitcnt lgkmcnt(6)
    v_mfma_f32_32x32x16_bf16 v[16:31], v[192:195], v[100:103], v[16:31]
    ds_read_b64_tr_b16 v[208:209], v215 offset:8
    ds_read_b64_tr_b16 v[210:211], v215 offset:1032
    s_waitcnt lgkmcnt(6)
    v_mfma_f32_32x32x16_bf16 v[32:47], v[196:199], v[100:103], v[32:47]
    s_waitcnt lgkmcnt(4)
    v_mfma_f32_32x32x16_bf16 v[48:63], v[200:203], v[100:103], v[48:63]
    s_waitcnt lgkmcnt(2)
    v_mfma_f32_16x16x32_bf16 v[64:67], v[204:207], v[104:107], v[64:67]
    s_waitcnt lgkmcnt(0)
    v_mfma_f32_16x16x32_bf16 v[68:71], v[208:211], v[104:107], v[68:71]
    s_cmp_eq_u32 s91, 1
    s_cbranch_scc1 L_k1_lax1
    s_waitcnt vmcnt(10)
L_k1_lax1:
    s_waitcnt vmcnt(20)
    s_barrier
    ds_read_b128 v[96:99], v213 offset:16384
    ds_read_b128 v[100:103], v247 offset:16384
    ds_read_b128 v[104:107], v214 offset:1024
    s_add_u32 m0, s9, 0x0
    s_add_u32 s10, s74, 0x0
    buffer_load_dwordx4 v239, s[56:59], s10 offen lds
    s_add_u32 m0, s9, 0x1000
    s_add_u32 s10, s74, 0x20000
    buffer_load_dwordx4 v239, s[56:59], s10 offen lds
    s_add_u32 m0, s76, 0x0
    s_add_u32 s74, s74, 0x40000
    buffer_load_dwordx4 v240, s[44:47], s75 offen lds
    s_add_u32 m0, s76, 0x400
    s_nop 0
    buffer_load_dwordx4 v212, s[44:47], s75 offen lds
    s_add_u32 m0, s77, 0x0
    s_mov_b64 exec, 0xffff
    buffer_load_dwordx4 v241, s[44:47], s75 offen lds
    s_mov_b64 exec, -1
    s_add_u32 s75, s75, 64
    ds_read_b64_tr_b16 v[192:193], v230 offset:16384
    ds_read_b64_tr_b16 v[194:195], v230 offset:17408
    ds_read_b64_tr_b16 v[196:197], v231 offset:16384
    ds_read_b64_tr_b16 v[198:199], v231 offset:17408
    ds_read_b64_tr_b16 v[200:201], v232 offset:16384
    ds_read_b64_tr_b16 v[202:203], v232 offset:17408
    ds_read_b64_tr_b16 v[204:205], v233 offset:16384
    ds_read_b64_tr_b16 v[206:207], v233 offset:17408
    s_waitcnt lgkmcnt(6)
    v_mfma_f32_32x32x16_bf16 v[0:15], v[192:195], v[96:99], v[0:15]
    ds_read_b64_tr_b16 v[208:209], v230 offset:20480
    ds_read_b64_tr_b16 v[210:211], v230 offset:21504
    s_waitcnt lgkmcnt(6)
    v_mfma_f32_32x32x16_bf16 v[16:31], v[196:199], v[96:99], v[16:31]
    ds_read_b64_tr_b16 v[192:193], v231 offset:20480
    ds_read_b64_tr_b16 v[194:195], v231 offset:21504
    s_waitcnt lgkmcnt(6)
    v_mfma_f32_32x32x16_bf16 v[32:47], v[200:203], v[96:99], v[32:47]
    ds_read_b64_tr_b16 v[196:197], v232 offset:20480
    ds_read_b64_tr_b16 v[198:199], v232 offset:21504
    s_waitcnt lgkmcnt(6)
    v_mfma_f32_32x32x16_bf16 v[48:63], v[204:207], v[96:99], v[48:63]
    ds_read_b64_tr_b16 v[200:201], v233 offset:20480
    ds_read_b64_tr_b16 v[202:203], v233 offset:21504
    s_waitcnt lgkmcnt(6)
    v_mfma_f32_32x32x16_bf16 v[0:15], v[208:211], v[100:103], v[0:15]
    ds_read_b64_tr_b16 v[204:205], v215 offset:16384
    ds_read_b64_tr_b16 v[206:207], v215 offset:17408
    s_waitcnt lgkmcnt(6)
    v_mfma_f32_32x32x16_bf16 v[16:31], v[192:195], v[100:103], v[16:31]
    ds_read_b64_tr_b16 v[208:209], v215 offset:16392
    ds_read_b64_tr_b16 v[210:211], v215 offset:17416
    s_waitcnt lgkmcnt(6)
    v_mfma_f32_32x32x16_bf16 v[32:47], v[196:199], v[100:103], v[32:47]
    s_waitcnt lgkmcnt(4)
    v_mfma_f32_32x32x16_bf16 v[48:63], v[200:203], v[100:103], v[48:63]
    s_waitcnt lgkmcnt(2)
    v_mfma_f32_16x16x32_bf16 v[64:67], v[204:207], v[104:107], v[64:67]
    s_waitcnt lgkmcnt(0)
    v_mfma_f32_16x16x32_bf16 v[68:71], v[208:211], v[104:107], v[68:71]
    s_cmp_eq_u32 s91, 1
    s_cbranch_scc1 L_k1_lax2
    s_waitcnt vmcnt(10)
L_k1_lax2:
    s_waitcnt vmcnt(20)
    s_barrier
    ds_read_b128 v[96:99], v213 offset:32768
    ds_read_b128 v[100:103], v247 offset:32768
    ds_read_b128 v[104:107], v214 offset:2048
    s_add_u32 m0, s9, 0x4000
    s_add_u32 s10, s74, 0x0
    buffer_load_dwordx4 v239, s[56:59], s10 offen lds
    s_add_u32 m0, s9, 0x5000
    s_add_u32 s10, s74, 0x20000
    buffer_load_dwordx4 v239, s[56:59], s10 offen lds
    s_add_u32 m0, s76, 0x4000
    s_add_u32 s74, s74, 0x40000
    buffer_load_dwordx4 v240, s[44:47], s75 offen lds
    s_add_u32 m0, s76, 0x4400
    s_nop 0
    buffer_load_dwordx4 v212, s[44:47], s75 offen lds
    s_add_u32 m0, s77, 0x400
    s_mov_b64 exec, 0xffff
    buffer_load_dwordx4 v241, s[44:47], s75 offen lds
    s_mov_b64 exec, -1
    s_add_u32 s75, s75, 64
    ds_read_b64_tr_b16 v[192:193], v230 offset:32768
    ds_read_b64_tr_b16 v[194:195], v230 offset:33792
    ds_read_b64_tr_b16 v[196:197], v231 offset:32768
    ds_read_b64_tr_b16 v[198:199], v231 offset:33792
    ds_read_b64_tr_b16 v[200:201], v232 offset:32768
    ds_read_b64_tr_b16 v[202:203], v232 offset:33792
    ds_read_b64_tr_b16 v[204:205], v233 offset:32768
    ds_read_b64_tr_b16 v[206:207], v233 offset:33792
    s_waitcnt lgkmcnt(6)
    v_mfma_f32_32x32x16_bf16 v[0:15], v[192:195], v[96:99], v[0:15]
    ds_read_b64_tr_b16 v[208:209], v230 offset:36864
    ds_read_b64_tr_b16 v[210:211], v230 offset:37888
    s_waitcnt lgkmcnt(6)
    v_mfma_f32_32x32x16_bf16 v[16:31], v[196:199], v[96:99], v[16:31]
    ds_read_b64_tr_b16 v[192:193], v231 offset:36864
    ds_read_b64_tr_b16 v[194:195], v231 offset:37888
    s_waitcnt lgkmcnt(6)
    v_mfma_f32_32x32x16_bf16 v[32:47], v[200:203], v[96:99], v[32:47]
    ds_read_b64_tr_b16 v[196:197], v232 offset:36864
    ds_read_b64_tr_b16 v[198:199], v232 offset:37888
    s_waitcnt lgkmcnt(6)
    v_mfma_f32_32x32x16_bf16 v[48:63], v[204:207], v[96:99], v[48:63]
    ds_read_b64_tr_b16 v[200:201], v233 offset:36864
    ds_read_b64_tr_b16 v[202:203], v233 offset:37888
    s_waitcnt lgkmcnt(6)
    v_mfma_f32_32x32x16_bf16 v[0:15], v[208:211], v[100:103], v[0:15]
    ds_read_b64_tr_b16 v[204:205], v215 offset:32768
    ds_read_b64_tr_b16 v[206:207], v215 offset:33792
    s_waitcnt lgkmcnt(6)
    v_mfma_f32_32x32x16_bf16 v[16:31], v[192:195], v[100:103], v[16:31]
    ds_read_b64_tr_b16 v[208:209], v215 offset:32776
    ds_read_b64_tr_b16 v[210:211], v215 offset:33800
    s_waitcnt lgkmcnt(6)
    v_mfma_f32_32x32x16_bf16 v[32:47], v[196:199], v[100:103], v[32:47]
    s_waitcnt lgkmcnt(4)
    v_mfma_f32_32x32x16_bf16 v[48:63], v[200:203], v[100:103], v[48:63]
    s_waitcnt lgkmcnt(2)
    v_mfma_f32_16x16x32_bf16 v[64:67], v[204:207], v[104:107], v[64:67]
    s_waitcnt lgkmcnt(0)
    v_mfma_f32_16x16x32_bf16 v[68:71], v[208:211], v[104:107], v[68:71]
    s_mov_b32 s91, 0
    s_waitcnt vmcnt(10)
    s_barrier
    ds_read_b128 v[96:99], v213 offset:49152
    ds_read_b128 v[100:103], v247 offset:49152
    ds_read_b128 v[104:107], v214 offset:3072
    s_add_u32 m0, s9, 0x8000
    s_add_u32 s10, s74, 0x0
    buffer_load_dwordx4 v239, s[56:59], s10 offen lds
    s_add_u32 m0, s9, 0x9000
    s_add_u32 s10, s74, 0x20000
    buffer_load_dwordx4 v239, s[56:59], s10 offen lds
    s_add_u32 m0, s76, 0x8000
    s_add_u32 s74, s74, 0x40000
    buffer_load_dwordx4 v240, s[44:47], s75 offen lds
    s_add_u32 m0, s76, 0x8400
    s_nop 0
    buffer_load_dwordx4 v212, s[44:47], s75 offen lds
    s_add_u32 m0, s77, 0x800
    s_mov_b64 exec, 0xffff
    buffer_load_dwordx4 v241, s[44:47], s75 offen lds
    s_mov_b64 exec, -1
    s_add_u32 s75, s75, 64
    ds_read_b64_tr_b16 v[192:193], v230 offset:49152
    ds_read_b64_tr_b16 v[194:195], v230 offset:50176
    ds_read_b64_tr_b16 v[196:197], v231 offset:49152
    ds_read_b64_tr_b16 v[198:199], v231 offset:50176
    ds_read_b64_tr_b16 v[200:201], v232 offset:49152
    ds_read_b64_tr_b16 v[202:203], v232 offset:50176
    ds_read_b64_tr_b16 v[204:205], v233 offset:49152
    ds_read_b64_tr_b16 v[206:207], v233 offset:50176
    s_waitcnt lgkmcnt(6)
    v_mfma_f32_32x32x16_bf16 v[0:15], v[192:195], v[96:99], v[0:15]
    ds_read_b64_tr_b16 v[208:209], v230 offset:53248
    ds_read_b64_tr_b16 v[210:211], v230 offset:54272
    s_waitcnt lgkmcnt(6)
    v_mfma_f32_32x32x16_bf16 v[16:31], v[196:199], v[96:99], v[16:31]
    ds_read_b64_tr_b16 v[192:193], v231 offset:53248
    ds_read_b64_tr_b16 v[194:195], v231 offset:54272
    s_waitcnt lgkmcnt(6)
    v_mfma_f32_32x32x16_bf16 v[32:47], v[200:203], v[96:99], v[32:47]
    ds_read_b64_tr_b16 v[196:197], v232 offset:53248
    ds_read_b64_tr_b16 v[198:199], v232 offset:54272
    s_waitcnt lgkmcnt(6)
    v_mfma_f32_32x32x16_bf16 v[48:63], v[204:207], v[96:99], v[48:63]
    ds_read_b64_tr_b16 v[200:201], v233 offset:53248
    ds_read_b64_tr_b16 v[202:203], v233 offset:54272
    s_waitcnt lgkmcnt(6)
    v_mfma_f32_32x32x16_bf16 v[0:15], v[208:211], v[100:103], v[0:15]
    ds_read_b64_tr_b16 v[204:205], v215 offset:49152
    ds_read_b64_tr_b16 v[206:207], v215 offset:50176
    s_waitcnt lgkmcnt(6)
    v_mfma_f32_32x32x16_bf16 v[16:31], v[192:195], v[100:103], v[16:31]
    ds_read_b64_tr_b16 v[208:209], v215 offset:49160
    ds_read_b64_tr_b16 v[210:211], v215 offset:50184
    s_waitcnt lgkmcnt(6)
    v_mfma_f32_32x32x16_bf16 v[32:47], v[196:199], v[100:103], v[32:47]
    s_waitcnt lgkmcnt(4)
    v_mfma_f32_32x32x16_bf16 v[48:63], v[200:203], v[100:103], v[48:63]
    s_waitcnt lgkmcnt(2)
    v_mfma_f32_16x16x32_bf16 v[64:67], v[204:207], v[104:107], v[64:67]
    s_waitcnt lgkmcnt(0)
    v_mfma_f32_16x16x32_bf16 v[68:71], v[208:211], v[104:107], v[68:71]
    s_add_u32 s27, s27, 1
    s_cmp_lt_u32 s27, 4
    s_cbranch_scc1 L_k1_qp
    s_waitcnt vmcnt(10)
    s_barrier
    ds_read_b128 v[96:99], v213 offset:0
    ds_read_b128 v[100:103], v247 offset:0
    ds_read_b128 v[104:107], v214 offset:0
    s_add_u32 m0, s9, 0xc000
    s_add_u32 s10, s74, 0x0
    buffer_load_dwordx4 v239, s[56:59], s10 offen lds
    s_add_u32 m0, s9, 0xd000
    s_add_u32 s10, s74, 0x20000
    buffer_load_dwordx4 v239, s[56:59], s10 offen lds
    s_add_u32 m0, s76, 0xc000
    s_add_u32 s74, s74, 0x40000
    buffer_load_dwordx4 v240, s[44:47], s75 offen lds
    s_add_u32 m0, s76, 0xc400
    s_nop 0
    buffer_load_dwordx4 v212, s[44:47], s75 offen lds
    s_add_u32 m0, s77, 0xc00
    s_mov_b64 exec, 0xffff
    buffer_load_dwordx4 v241, s[44:47], s75 offen lds
    s_mov_b64 exec, -1
    s_add_u32 s75, s75, 64
    s_mov_b32 s74, s73
    s_mov_b32 s75, 0
    s_cmp_eq_u32 s28, 0
    s_cbranch_scc0 L_k1_nog
    buffer_load_ushort v144, v184, s[60:63], s17 offen offset:0
    buffer_load_ushort v145, v184, s[60:63], s17 offen offset:1280
    buffer_load_ushort v146, v184, s[60:63], s18 offen offset:0
    buffer_load_ushort v147, v184, s[60:63], s18 offen offset:1280
    buffer_load_ushort v148, v184, s[60:63], s19 offen offset:0
    buffer_load_ushort v149, v184, s[60:63], s19 offen offset:1280
    buffer_load_ushort v150, v184, s[60:63], s20 offen offset:0
    buffer_load_ushort v151, v184, s[60:63], s20 offen offset:1280
    buffer_load_ushort v152, v184, s[60:63], s17 offen offset:32
    buffer_load_ushort v153, v184, s[60:63], s17 offen offset:1312
    buffer_load_ushort v154, v184, s[60:63], s18 offen offset:32
    buffer_load_ushort v155, v184, s[60:63], s18 offen offset:1312
    buffer_load_ushort v156, v184, s[60:63], s19 offen offset:32
    buffer_load_ushort v157, v184, s[60:63], s19 offen offset:1312
    buffer_load_ushort v158, v184, s[60:63], s20 offen offset:32
    buffer_load_ushort v159, v184, s[60:63], s20 offen offset:1312
    buffer_load_ushort v160, v184, s[60:63], s17 offen offset:64
    buffer_load_ushort v161, v184, s[60:63], s17 offen offset:1344
    buffer_load_ushort v162, v184, s[60:63], s18 offen offset:64
    buffer_load_ushort v163, v184, s[60:63], s18 offen offset:1344
    buffer_load_ushort v164, v184, s[60:63], s19 offen offset:64
    buffer_load_ushort v165, v184, s[60:63], s19 offen offset:1344
    buffer_load_ushort v166, v184, s[60:63], s20 offen offset:64
    buffer_load_ushort v167, v184, s[60:63], s20 offen offset:1344
    buffer_load_ushort v168, v184, s[60:63], s17 offen offset:96
    buffer_load_ushort v169, v184, s[60:63], s17 offen offset:1376
    buffer_load_ushort v170, v184, s[60:63], s18 offen offset:96
    buffer_load_ushort v171, v184, s[60:63], s18 offen offset:1376
    buffer_load_ushort v172, v184, s[60:63], s19 offen offset:96
    buffer_load_ushort v173, v184, s[60:63], s19 offen offset:1376
    buffer_load_ushort v174, v184, s[60:63], s20 offen offset:96
    buffer_load_ushort v175, v184, s[60:63], s20 offen offset:1376
    buffer_load_ushort v176, v184, s[60:63], s17 offen offset:128
    buffer_load_ushort v177, v184, s[60:63], s17 offen offset:1408
    buffer_load_ushort v178, v184, s[60:63], s18 offen offset:128
    buffer_load_ushort v179, v184, s[60:63], s18 offen offset:1408
    buffer_load_ushort v180, v184, s[60:63], s19 offen offset:128
    buffer_load_ushort v181, v184, s[60:63], s19 offen offset:1408
    buffer_load_ushort v182, v184, s[60:63], s20 offen offset:128
    buffer_load_ushort v183, v184, s[60:63], s20 offen offset:1408
L_k1_nog:
    ds_read_b64_tr_b16 v[192:193], v230 offset:0
    ds_read_b64_tr_b16 v[194:195], v230 offset:1024
    ds_read_b64_tr_b16 v[196:197], v231 offset:0
    ds_read_b64_tr_b16 v[198:199], v231 offset:1024
    ds_read_b64_tr_b16 v[200:201], v232 offset:0
    ds_read_b64_tr_b16 v[202:203], v232 offset:1024
    ds_read_b64_tr_b16 v[204:205], v233 offset:0
    ds_read_b64_tr_b16 v[206:207], v233 offset:1024
    s_waitcnt lgkmcnt(6)
    v_mfma_f32_32x32x16_bf16 v[0:15], v[192:195], v[96:99], v[0:15]
    ds_read_b64_tr_b16 v[208:209], v230 offset:4096
    ds_read_b64_tr_b16 v[210:211], v230 offset:5120
    s_waitcnt lgkmcnt(6)
    v_mfma_f32_32x32x16_bf16 v[16:31], v[196:199], v[96:99], v[16:31]
    ds_read_b64_tr_b16 v[192:193], v231 offset:4096
    ds_read_b64_tr_b16 v[194:195], v231 offset:5120
    s_waitcnt lgkmcnt(6)
    v_mfma_f32_32x32x16_bf16 v[32:47], v[200:203], v[96:99], v[32:47]
    ds_read_b64_tr_b16 v[196:197], v232 offset:4096
    ds_read_b64_tr_b16 v[198:199], v232 offset:5120
    s_waitcnt lgkmcnt(6)
    v_mfma_f32_32x32x16_bf16 v[48:63], v[204:207], v[96:99], v[48:63]
    ds_read_b64_tr_b16 v[200:201], v233 offset:4096
    ds_read_b64_tr_b16 v[202:203], v233 offset:5120
    s_waitcnt lgkmcnt(6)
    v_mfma_f32_32x32x16_bf16 v[0:15], v[208:211], v[100:103], v[0:15]
    ds_read_b64_tr_b16 v[204:205], v215 offset:0
    ds_read_b64_tr_b16 v[206:207], v215 offset:1024
    s_waitcnt lgkmcnt(6)
    v_mfma_f32_32x32x16_bf16 v[16:31], v[192:195], v[100:103], v[16:31]
    ds_read_b64_tr_b16 v[208:209], v215 offset:8
    ds_read_b64_tr_b16 v[210:211], v215 offset:1032
    s_waitcnt lgkmcnt(6)
    v_mfma_f32_32x32x16_bf16 v[32:47], v[196:199], v[100:103], v[32:47]
    s_waitcnt lgkmcnt(4)
    v_mfma_f32_32x32x16_bf16 v[48:63], v[200:203], v[100:103], v[48:63]
    s_waitcnt lgkmcnt(2)
    v_mfma_f32_16x16x32_bf16 v[64:67], v[204:207], v[104:107], v[64:67]
    s_waitcnt lgkmcnt(0)
    v_mfma_f32_16x16x32_bf16 v[68:71], v[208:211], v[104:107], v[68:71]
    s_cmp_eq_u32 s28, 0
    s_cbranch_scc1 L_k1_lax5
    s_waitcnt vmcnt(10)
L_k1_lax5:
    s_waitcnt vmcnt(50)
    s_barrier
    ds_read_b128 v[96:99], v213 offset:16384
    ds_read_b128 v[100:103], v247 offset:16384
    ds_read_b128 v[104:107], v214 offset:1024
    s_cmp_eq_u32 s79, 1
    s_cbranch_scc1 L_w_1
    s_add_u32 s10, s7, s72
    s_and_b32 s10, s10, 0x1ffff
    s_and_b32 s13, s7, 0x20000
    s_add_u32 s10, s10, s13
    s_add_u32 s10, s10, s42
    s_cmp_lt_u32 s7, 0x40000
    s_cselect_b32 s10, s10, 0x7f000000
    s_add_u32 m0, s9, 0x0
    s_add_u32 s7, s7, 16384
    buffer_load_dwordx4 v237, s[48:51], s10 offen nt lds
    s_add_u32 m0, s9, 0x1000
    s_add_u32 s10, s10, 4096
    buffer_load_dwordx4 v237, s[48:51], s10 offen nt lds
    s_add_u32 m0, s9, 0x2000
    s_add_u32 s10, s10, 4096
    buffer_load_dwordx4 v237, s[48:51], s10 offen nt lds
    s_add_u32 m0, s9, 0x3000
    s_add_u32 s10, s10, 4096
    buffer_load_dwordx4 v237, s[48:51], s10 offen nt lds
    s_branch L_e_2
L_w_1:
    s_add_u32 m0, s9, 0x0
    s_add_u32 s10, s74, 0x0
    buffer_load_dwordx4 v239, s[56:59], s10 offen lds
    s_add_u32 m0, s9, 0x1000
    s_add_u32 s10, s74, 0x20000
    buffer_load_dwordx4 v239, s[56:59], s10 offen lds
    s_add_u32 m0, s76, 0x0
    s_add_u32 s74, s74, 0x40000
    buffer_load_dwordx4 v240, s[44:47], s75 offen lds
    s_add_u32 m0, s76, 0x400
    s_nop 0
    buffer_load_dwordx4 v212, s[44:47], s75 offen lds
    s_add_u32 m0, s77, 0x0
    s_mov_b64 exec, 0xffff
    buffer_load_dwordx4 v241, s[44:47], s75 offen lds
    s_mov_b64 exec, -1
    s_add_u32 s75, s75, 64
L_e_2:
    ds_read_b64_tr_b16 v[192:193], v230 offset:16384
    ds_read_b64_tr_b16 v[194:195], v230 offset:17408
    ds_read_b64_tr_b16 v[196:197], v231 offset:16384
    ds_read_b64_tr_b16 v[198:199], v231 offset:17408
    ds_read_b64_tr_b16 v[200:201], v232 offset:16384
    ds_read_b64_tr_b16 v[202:203], v232 offset:17408
    ds_read_b64_tr_b16 v[204:205], v233 offset:16384
    ds_read_b64_tr_b16 v[206:207], v233 offset:17408
    s_waitcnt lgkmcnt(6)
    v_mfma_f32_32x32x16_bf16 v[0:15], v[192:195], v[96:99], v[0:15]
    ds_read_b64_tr_b16 v[208:209], v230 offset:20480
    ds_read_b64_tr_b16 v[210:211], v230 offset:21504
    s_waitcnt lgkmcnt(6)
    v_mfma_f32_32x32x16_bf16 v[16:31], v[196:199], v[96:99], v[16:31]
    ds_read_b64_tr_b16 v[192:193], v231 offset:20480
    ds_read_b64_tr_b16 v[194:195], v231 offset:21504
    s_waitcnt lgkmcnt(6)
    v_mfma_f32_32x32x16_bf16 v[32:47], v[200:203], v[96:99], v[32:47]
    ds_read_b64_tr_b16 v[196:197], v232 offset:20480
    ds_read_b64_tr_b16 v[198:199], v232 offset:21504
    s_waitcnt lgkmcnt(6)
    v_mfma_f32_32x32x16_bf16 v[48:63], v[204:207], v[96:99], v[48:63]
    ds_read_b64_tr_b16 v[200:201], v233 offset:20480
    ds_read_b64_tr_b16 v[202:203], v233 offset:21504
    s_waitcnt lgkmcnt(6)
    v_mfma_f32_32x32x16_bf16 v[0:15], v[208:211], v[100:103], v[0:15]
    ds_read_b64_tr_b16 v[204:205], v215 offset:16384
    ds_read_b64_tr_b16 v[206:207], v215 offset:17408
    s_waitcnt lgkmcnt(6)
    v_mfma_f32_32x32x16_bf16 v[16:31], v[192:195], v[100:103], v[16:31]
    ds_read_b64_tr_b16 v[208:209], v215 offset:16392
    ds_read_b64_tr_b16 v[210:211], v215 offset:17416
    s_waitcnt lgkmcnt(6)
    v_mfma_f32_32x32x16_bf16 v[32:47], v[196:199], v[100:103], v[32:47]
    s_waitcnt lgkmcnt(4)
    v_mfma_f32_32x32x16_bf16 v[48:63], v[200:203], v[100:103], v[48:63]
    s_waitcnt lgkmcnt(2)
    v_mfma_f32_16x16x32_bf16 v[64:67], v[204:207], v[104:107], v[64:67]
    s_waitcnt lgkmcnt(0)
    v_mfma_f32_16x16x32_bf16 v[68:71], v[208:211], v[104:107], v[68:71]
    s_cmp_eq_u32 s28, 0
    s_cbranch_scc1 L_k1_lax6
    s_waitcnt vmcnt(8)
L_k1_lax6:
    s_waitcnt vmcnt(49)
    s_barrier
    ds_read_b128 v[96:99], v213 offset:32768
    ds_read_b128 v[100:103], v247 offset:32768
    ds_read_b128 v[104:107], v214 offset:2048
    s_cmp_eq_u32 s79, 1
    s_cbranch_scc1 L_w_3
    s_add_u32 s10, s8, s72
    s_and_b32 s10, s10, 0x1ffff
    s_and_b32 s13, s8, 0x20000
    s_add_u32 s10, s10, s13
    s_add_u32 s10, s10, s42
    s_cmp_lt_u32 s8, 0x40000
    s_cselect_b32 s10, s10, 0x7f000000
    s_add_u32 m0, s9, 0x4000
    s_add_u32 s8, s8, 16384
    buffer_load_dwordx4 v238, s[52:55], s10 offen nt lds
    s_add_u32 m0, s9, 0x5000
    s_add_u32 s10, s10, 4096
    buffer_load_dwordx4 v238, s[52:55], s10 offen nt lds
    s_add_u32 m0, s9, 0x6000
    s_add_u32 s10, s10, 4096
    buffer_load_dwordx4 v238, s[52:55], s10 offen nt lds
    s_add_u32 m0, s9, 0x7000
    s_add_u32 s10, s10, 4096
    buffer_load_dwordx4 v238, s[52:55], s10 offen nt lds
    s_branch L_e_4
L_w_3:
    s_add_u32 m0, s9, 0x4000
    s_add_u32 s10, s74, 0x0
    buffer_load_dwordx4 v239, s[56:59], s10 offen lds
    s_add_u32 m0, s9, 0x5000
    s_add_u32 s10, s74, 0x20000
    buffer_load_dwordx4 v239, s[56:59], s10 offen lds
    s_add_u32 m0, s76, 0x4000
    s_add_u32 s74, s74, 0x40000
    buffer_load_dwordx4 v240, s[44:47], s75 offen lds
    s_add_u32 m0, s76, 0x4400
    s_nop 0
    buffer_load_dwordx4 v212, s[44:47], s75 offen lds
    s_add_u32 m0, s77, 0x400
    s_mov_b64 exec, 0xffff
    buffer_load_dwordx4 v241, s[44:47], s75 offen lds
    s_mov_b64 exec, -1
    s_add_u32 s75, s75, 64
L_e_4:
    ds_read_b64_tr_b16 v[192:193], v230 offset:32768
    ds_read_b64_tr_b16 v[194:195], v230 offset:33792
    ds_read_b64_tr_b16 v[196:197], v231 offset:32768
    ds_read_b64_tr_b16 v[198:199], v231 offset:33792
    ds_read_b64_tr_b16 v[200:201], v232 offset:32768
    ds_read_b64_tr_b16 v[202:203], v232 offset:33792
    ds_read_b64_tr_b16 v[204:205], v233 offset:32768
    ds_read_b64_tr_b16 v[206:207], v233 offset:33792
    s_waitcnt lgkmcnt(6)
    v_mfma_f32_32x32x16_bf16 v[0:15], v[192:195], v[96:99], v[0:15]
    ds_read_b64_tr_b16 v[208:209], v230 offset:36864
    ds_read_b64_tr_b16 v[210:211], v230 offset:37888
    s_waitcnt lgkmcnt(6)
    v_mfma_f32_32x32x16_bf16 v[16:31], v[196:199], v[96:99], v[16:31]
    ds_read_b64_tr_b16 v[192:193], v231 offset:36864
    ds_read_b64_tr_b16 v[194:195], v231 offset:37888
    s_waitcnt lgkmcnt(6)
    v_mfma_f32_32x32x16_bf16 v[32:47], v[200:203], v[96:99], v[32:47]
    ds_read_b64_tr_b16 v[196:197], v232 offset:36864
    ds_read_b64_tr_b16 v[198:199], v232 offset:37888
    s_waitcnt lgkmcnt(6)
    v_mfma_f32_32x32x16_bf16 v[48:63], v[204:207], v[96:99], v[48:63]
    ds_read_b64_tr_b16 v[200:201], v233 offset:36864
    ds_read_b64_tr_b16 v[202:203], v233 offset:37888
    s_waitcnt lgkmcnt(6)
    v_mfma_f32_32x32x16_bf16 v[0:15], v[208:211], v[100:103], v[0:15]
    ds_read_b64_tr_b16 v[204:205], v215 offset:32768
    ds_read_b64_tr_b16 v[206:207], v215 offset:33792
    s_waitcnt lgkmcnt(6)
    v_mfma_f32_32x32x16_bf16 v[16:31], v[192:195], v[100:103], v[16:31]
    ds_read_b64_tr_b16 v[208:209], v215 offset:32776
    ds_read_b64_tr_b16 v[210:211], v215 offset:33800
    s_waitcnt lgkmcnt(6)
    v_mfma_f32_32x32x16_bf16 v[32:47], v[196:199], v[100:103], v[32:47]
    s_waitcnt lgkmcnt(4)
    v_mfma_f32_32x32x16_bf16 v[48:63], v[200:203], v[100:103], v[48:63]
    s_waitcnt lgkmcnt(2)
    v_mfma_f32_16x16x32_bf16 v[64:67], v[204:207], v[104:107], v[64:67]
    s_waitcnt lgkmcnt(0)
    v_mfma_f32_16x16x32_bf16 v[68:71], v[208:211], v[104:107], v[68:71]
    s_cmp_eq_u32 s28, 0
    s_cbranch_scc1 L_k1_lax7
    s_waitcnt vmcnt(8)
L_k1_lax7:
    s_waitcnt vmcnt(48)
    s_barrier
    ds_read_b128 v[96:99], v213 offset:49152
    ds_read_b128 v[100:103], v247 offset:49152
    ds_read_b128 v[104:107], v214 offset:3072
    s_cmp_eq_u32 s79, 1
    s_cbranch_scc1 L_w_5
    s_add_u32 s10, s7, s72
    s_and_b32 s10, s10, 0x1ffff
    s_and_b32 s13, s7, 0x20000
    s_add_u32 s10, s10, s13
    s_add_u32 s10, s10, s42
    s_cmp_lt_u32 s7, 0x40000
    s_cselect_b32 s10, s10, 0x7f000000
    s_add_u32 m0, s9, 0x8000
    s_add_u32 s7, s7, 16384
    buffer_load_dwordx4 v237, s[48:51], s10 offen nt lds
    s_add_u32 m0, s9, 0x9000
    s_add_u32 s10, s10, 4096
    buffer_load_dwordx4 v237, s[48:51], s10 offen nt lds
    s_add_u32 m0, s9, 0xa000
    s_add_u32 s10, s10, 4096
    buffer_load_dwordx4 v237, s[48:51], s10 offen nt lds
    s_add_u32 m0, s9, 0xb000
    s_add_u32 s10, s10, 4096
    buffer_load_dwordx4 v237, s[48:51], s10 offen nt lds
    s_branch L_e_6
L_w_5:
    s_add_u32 m0, s9, 0x8000
    s_add_u32 s10, s74, 0x0
    buffer_load_dwordx4 v239, s[56:59], s10 offen lds
    s_add_u32 m0, s9, 0x9000
    s_add_u32 s10, s74, 0x20000
    buffer_load_dwordx4 v239, s[56:59], s10 offen lds
    s_add_u32 m0, s76, 0x8000
    s_add_u32 s74, s74, 0x40000
    buffer_load_dwordx4 v240, s[44:47], s75 offen lds
    s_add_u32 m0, s76, 0x8400
    s_nop 0
    buffer_load_dwordx4 v212, s[44:47], s75 offen lds
    s_add_u32 m0, s77, 0x800
    s_mov_b64 exec, 0xffff
    buffer_load_dwordx4 v241, s[44:47], s75 offen lds
    s_mov_b64 exec, -1
    s_add_u32 s75, s75, 64
L_e_6:
    ds_read_b64_tr_b16 v[192:193], v230 offset:49152
    ds_read_b64_tr_b16 v[194:195], v230 offset:50176
    ds_read_b64_tr_b16 v[196:197], v231 offset:49152
    ds_read_b64_tr_b16 v[198:199], v231 offset:50176
    ds_read_b64_tr_b16 v[200:201], v232 offset:49152
    ds_read_b64_tr_b16 v[202:203], v232 offset:50176
    ds_read_b64_tr_b16 v[204:205], v233 offset:49152
    ds_read_b64_tr_b16 v[206:207], v233 offset:50176
    s_waitcnt lgkmcnt(6)
    v_mfma_f32_32x32x16_bf16 v[0:15], v[192:195], v[96:99], v[0:15]
    ds_read_b64_tr_b16 v[208:209], v230 offset:53248
    ds_read_b64_tr_b16 v[210:211], v230 offset:54272
    s_waitcnt lgkmcnt(6)
    v_mfma_f32_32x32x16_bf16 v[16:31], v[196:199], v[96:99], v[16:31]
    ds_read_b64_tr_b16 v[192:193], v231 offset:53248
    ds_read_b64_tr_b16 v[194:195], v231 offset:54272
    s_waitcnt lgkmcnt(6)
    v_mfma_f32_32x32x16_bf16 v[32:47], v[200:203], v[96:99], v[32:47]
    ds_read_b64_tr_b16 v[196:197], v232 offset:53248
    ds_read_b64_tr_b16 v[198:199], v232 offset:54272
    s_waitcnt lgkmcnt(6)
    v_mfma_f32_32x32x16_bf16 v[48:63], v[204:207], v[96:99], v[48:63]
    ds_read_b64_tr_b16 v[200:201], v233 offset:53248
    ds_read_b64_tr_b16 v[202:203], v233 offset:54272
    s_waitcnt lgkmcnt(6)
    v_mfma_f32_32x32x16_bf16 v[0:15], v[208:211], v[100:103], v[0:15]
    ds_read_b64_tr_b16 v[204:205], v215 offset:49152
    ds_read_b64_tr_b16 v[206:207], v215 offset:50176
    s_waitcnt lgkmcnt(6)
    v_mfma_f32_32x32x16_bf16 v[16:31], v[192:195], v[100:103], v[16:31]
    ds_read_b64_tr_b16 v[208:209], v215 offset:49160
    ds_read_b64_tr_b16 v[210:211], v215 offset:50184
    s_waitcnt lgkmcnt(6)
    v_mfma_f32_32x32x16_bf16 v[32:47], v[196:199], v[100:103], v[32:47]
    s_waitcnt lgkmcnt(4)
    v_mfma_f32_32x32x16_bf16 v[48:63], v[200:203], v[100:103], v[48:63]
    s_waitcnt lgkmcnt(2)
    v_mfma_f32_16x16x32_bf16 v[64:67], v[204:207], v[104:107], v[64:67]
    s_waitcnt lgkmcnt(0)
    v_mfma_f32_16x16x32_bf16 v[68:71], v[208:211], v[104:107], v[68:71]
    s_nop 7
    s_nop 7
    v_cvt_pk_bf16_f32 v216, v64, v65
    v_cvt_pk_bf16_f32 v217, v66, v67
    v_cvt_pk_bf16_f32 v218, v68, v69
    v_cvt_pk_bf16_f32 v219, v70, v71
    s_lshl_b32 s10, s3, 10
    s_add_u32 s10, s10, 0x10000
    v_add_u32 v246, s10, v255
    ds_write_b128 v246, v[216:219]
    v_cvt_pk_bf16_f32 v96, v0, v1
    v_cvt_pk_bf16_f32 v97, v2, v3
    v_cvt_pk_bf16_f32 v98, v4, v5
    v_cvt_pk_bf16_f32 v99, v6, v7
    v_cvt_pk_bf16_f32 v100, v8, v9
    v_cvt_pk_bf16_f32 v101, v10, v11
    v_cvt_pk_bf16_f32 v102, v12, v13
    v_cvt_pk_bf16_f32 v103, v14, v15
    v_cvt_pk_bf16_f32 v104, v16, v17
    v_cvt_pk_bf16_f32 v105, v18, v19
    v_cvt_pk_bf16_f32 v106, v20, v21
    v_cvt_pk_bf16_f32 v107, v22, v23
    v_cvt_pk_bf16_f32 v108, v24, v25
    v_cvt_pk_bf16_f32 v109, v26, v27
    v_cvt_pk_bf16_f32 v110, v28, v29
    v_cvt_pk_bf16_f32 v111, v30, v31
    v_cvt_pk_bf16_f32 v112, v32, v33
    v_cvt_pk_bf16_f32 v113, v34, v35
    v_cvt_pk_bf16_f32 v114, v36, v37
    v_cvt_pk_bf16_f32 v115, v38, v39
    v_cvt_pk_bf16_f32 v116, v40, v41
    v_cvt_pk_bf16_f32 v117, v42, v43
    v_cvt_pk_bf16_f32 v118, v44, v45
    v_cvt_pk_bf16_f32 v119, v46, v47
    v_cvt_pk_bf16_f32 v120, v48, v49
    v_cvt_pk_bf16_f32 v121, v50, v51
    v_cvt_pk_bf16_f32 v122, v52, v53
    v_cvt_pk_bf16_f32 v123, v54, v55
    v_cvt_pk_bf16_f32 v124, v56, v57
    v_cvt_pk_bf16_f32 v125, v58, v59
    v_cvt_pk_bf16_f32 v126, v60, v61
    v_cvt_pk_bf16_f32 v127, v62, v63
    s_waitcnt lgkmcnt(0)
    s_barrier
    v_add_u32 v246, 0x10000, v255
    ds_read_b128 v[128:131], v246 offset:0
    ds_read_b128 v[132:135], v246 offset:1024
    ds_read_b128 v[136:139], v246 offset:2048
    ds_read_b128 v[140:143], v246 offset:3072
    s_cmp_eq_u32 s79, 1
    s_cbranch_scc0 L_k1_att
    s_waitcnt lgkmcnt(0)
    buffer_store_dwordx4 v[96:99], v255, s[80:83], s84 offen offset:0 sc0 sc1
    buffer_store_dwordx4 v[100:103], v255, s[80:83], s84 offen offset:1024 sc0 sc1
    buffer_store_dwordx4 v[104:107], v255, s[80:83], s84 offen offset:2048 sc0 sc1
    buffer_store_dwordx4 v[108:111], v255, s[80:83], s84 offen offset:3072 sc0 sc1
    buffer_store_dwordx4 v[112:115], v255, s[80:83], s85 offen offset:0 sc0 sc1
    buffer_store_dwordx4 v[116:119], v255, s[80:83], s85 offen offset:1024 sc0 sc1
    buffer_store_dwordx4 v[120:123], v255, s[80:83], s85 offen offset:2048 sc0 sc1
    buffer_store_dwordx4 v[124:127], v255, s[80:83], s85 offen offset:3072 sc0 sc1
    buffer_store_dwordx4 v[128:131], v255, s[80:83], s86 offen offset:0 sc0 sc1
    buffer_store_dwordx4 v[132:135], v255, s[80:83], s86 offen offset:1024 sc0 sc1
    buffer_store_dwordx4 v[136:139], v255, s[80:83], s86 offen offset:2048 sc0 sc1
    buffer_store_dwordx4 v[140:143], v255, s[80:83], s86 offen offset:3072 sc0 sc1
    s_mov_b32 s79, 0
    s_branch L_k1_head
L_k1_att:
    s_cmp_eq_u32 s28, 0
    s_cbranch_scc0 L_k1_nos
    s_waitcnt vmcnt(12)
    v_lshl_or_b32 v144, v145, 16, v144
    v_lshl_or_b32 v145, v147, 16, v146
    v_lshl_or_b32 v146, v149, 16, v148
    v_lshl_or_b32 v147, v151, 16, v150
    buffer_store_dwordx4 v[144:147], v255, s[68:71], s23 offen offset:0 sc0 sc1
    v_lshl_or_b32 v152, v153, 16, v152
    v_lshl_or_b32 v153, v155, 16, v154
    v_lshl_or_b32 v154, v157, 16, v156
    v_lshl_or_b32 v155, v159, 16, v158
    buffer_store_dwordx4 v[152:155], v255, s[68:71], s23 offen offset:1024 sc0 sc1
    v_lshl_or_b32 v160, v161, 16, v160
    v_lshl_or_b32 v161, v163, 16, v162
    v_lshl_or_b32 v162, v165, 16, v164
    v_lshl_or_b32 v163, v167, 16, v166
    buffer_store_dwordx4 v[160:163], v255, s[68:71], s23 offen offset:2048 sc0 sc1
    v_lshl_or_b32 v168, v169, 16, v168
    v_lshl_or_b32 v169, v171, 16, v170
    v_lshl_or_b32 v170, v173, 16, v172
    v_lshl_or_b32 v171, v175, 16, v174
    buffer_store_dwordx4 v[168:171], v255, s[68:71], s23 offen offset:3072 sc0 sc1
    v_lshl_or_b32 v176, v177, 16, v176
    v_lshl_or_b32 v177, v179, 16, v178
    v_lshl_or_b32 v178, v181, 16, v180
    v_lshl_or_b32 v179, v183, 16, v182
    buffer_store_dwordx4 v[176:179], v255, s[68:71], s24 offen offset:0 sc0 sc1
L_k1_nos:
    s_xor_b32 s91, s28, 1
    v_mov_b32 v0, 0
    v_mov_b32 v1, 0
    v_mov_b32 v2, 0
    v_mov_b32 v3, 0
    v_mov_b32 v4, 0
    v_mov_b32 v5, 0
    v_mov_b32 v6, 0
    v_mov_b32 v7, 0
    v_mov_b32 v8, 0
    v_mov_b32 v9, 0
    v_mov_b32 v10, 0
    v_mov_b32 v11, 0
    v_mov_b32 v12, 0
    v_mov_b32 v13, 0
    v_mov_b32 v14, 0
    v_mov_b32 v15, 0
    v_mov_b32 v16, 0
    v_mov_b32 v17, 0
    v_mov_b32 v18, 0
    v_mov_b32 v19, 0
    v_mov_b32 v20, 0
    v_mov_b32 v21, 0
    v_mov_b32 v22, 0
    v_mov_b32 v23, 0
    v_mov_b32 v24, 0
    v_mov_b32 v25, 0
    v_mov_b32 v26, 0
    v_mov_b32 v27, 0
    v_mov_b32 v28, 0
    v_mov_b32 v29, 0
    v_mov_b32 v30, 0
    v_mov_b32 v31, 0
    v_mov_b32 v32, 0
    v_mov_b32 v33, 0
    v_mov_b32 v34, 0
    v_mov_b32 v35, 0
    v_mov_b32 v36, 0
    v_mov_b32 v37, 0
    v_mov_b32 v38, 0
    v_mov_b32 v39, 0
    v_mov_b32 v40, 0
    v_mov_b32 v41, 0
    v_mov_b32 v42, 0
    v_mov_b32 v43, 0
    v_mov_b32 v44, 0
    v_mov_b32 v45, 0
    v_mov_b32 v46, 0
    v_mov_b32 v47, 0
    v_mov_b32 v48, 0
    v_mov_b32 v49, 0
    v_mov_b32 v50, 0
    v_mov_b32 v51, 0
    v_mov_b32 v52, 0
    v_mov_b32 v53, 0
    v_mov_b32 v54, 0
    v_mov_b32 v55, 0
    v_mov_b32 v56, 0
    v_mov_b32 v57, 0
    v_mov_b32 v58, 0
    v_mov_b32 v59, 0
    v_mov_b32 v60, 0
    v_mov_b32 v61, 0
    v_mov_b32 v62, 0
    v_mov_b32 v63, 0
    v_mov_b32 v64, 0
    v_mov_b32 v65, 0
    v_mov_b32 v66, 0
    v_mov_b32 v67, 0
    v_mov_b32 v68, 0
    v_mov_b32 v69, 0
    v_mov_b32 v70, 0
    v_mov_b32 v71, 0
    v_mov_b32 v72, 0
    v_mov_b32 v73, 0
    v_mov_b32 v74, 0
    v_mov_b32 v75, 0
    v_mov_b32 v76, 0
    v_mov_b32 v77, 0
    v_mov_b32 v78, 0
    v_mov_b32 v79, 0
    v_mov_b32 v80, 0
    v_mov_b32 v81, 0
    v_mov_b32 v82, 0
    v_mov_b32 v83, 0
    v_mov_b32 v84, 0
    v_mov_b32 v85, 0
    v_mov_b32 v86, 0
    v_mov_b32 v87, 0
    v_mov_b32 v88, 0
    v_mov_b32 v89, 0
    v_mov_b32 v90, 0
    v_mov_b32 v91, 0
    v_mov_b32 v92, 0
    v_mov_b32 v93, 0
    v_mov_b32 v94, 0
    v_mov_b32 v95, 0
    v_mov_b32 v242, 0xf149f2ca
    v_mov_b32 v244, 0xf149f2ca
    v_mov_b32 v243, 0
    v_mov_b32 v245, 0
    s_mov_b32 s27, 0
    s_or_b32 s87, s28, s78
L_k1_blk:
    s_cmp_eq_u32 s91, 1
    s_cbranch_scc1 L_k1_alax0
    s_waitcnt vmcnt(8)
L_k1_alax0:
    s_waitcnt vmcnt(13)
    s_barrier
    s_add_u32 s10, s8, s72
    s_and_b32 s10, s10, 0x1ffff
    s_and_b32 s13, s8, 0x20000
    s_add_u32 s10, s10, s13
    s_add_u32 s10, s10, s42
    s_cmp_lt_u32 s8, 0x40000
    s_cselect_b32 s10, s10, 0x7f000000
    s_add_u32 m0, s9, 0xc000
    s_add_u32 s8, s8, 16384
    buffer_load_dwordx4 v238, s[52:55], s10 offen nt lds
    s_add_u32 m0, s9, 0xd000
    s_add_u32 s10, s10, 4096
    buffer_load_dwordx4 v238, s[52:55], s10 offen nt lds
    s_add_u32 m0, s9, 0xe000
    s_add_u32 s10, s10, 4096
    buffer_load_dwordx4 v238, s[52:55], s10 offen nt lds
    s_add_u32 m0, s9, 0xf000
    s_add_u32 s10, s10, 4096
    buffer_load_dwordx4 v238, s[52:55], s10 offen nt lds
    v_xor_b32 v247, 64, v234
    v_xor_b32 v248, 128, v234
    v_xor_b32 v249, 192, v234
    ds_read_b128 v[192:195], v222 offset:0
    ds_read_b128 v[196:199], v223 offset:0
    ds_read_b128 v[200:203], v224 offset:0
    ds_read_b128 v[204:207], v225 offset:0
    s_waitcnt lgkmcnt(3)
    v_mfma_f32_32x32x16_bf16 v[144:159], v[192:195], v[96:99], 0
    ds_read_b128 v[208:211], v226 offset:0
    s_waitcnt lgkmcnt(3)
    v_mfma_f32_32x32x16_bf16 v[144:159], v[196:199], v[100:103], v[144:159]
    ds_read_b128 v[192:195], v227 offset:0
    s_waitcnt lgkmcnt(3)
    v_mfma_f32_32x32x16_bf16 v[144:159], v[200:203], v[104:107], v[144:159]
    ds_read_b128 v[196:199], v228 offset:0
    s_waitcnt lgkmcnt(3)
    v_mfma_f32_32x32x16_bf16 v[144:159], v[204:207], v[108:111], v[144:159]
    ds_read_b128 v[200:203], v229 offset:0
    s_waitcnt lgkmcnt(3)
    v_mfma_f32_32x32x16_bf16 v[144:159], v[208:211], v[112:115], v[144:159]
    ds_read_b128 v[204:207], v222 offset:8192
    s_waitcnt lgkmcnt(3)
    v_mfma_f32_32x32x16_bf16 v[144:159], v[192:195], v[116:119], v[144:159]
    ds_read_b128 v[208:211], v223 offset:8192
    s_waitcnt lgkmcnt(3)
    v_mfma_f32_32x32x16_bf16 v[144:159], v[196:199], v[120:123], v[144:159]
    ds_read_b128 v[192:195], v224 offset:8192
    s_waitcnt lgkmcnt(3)
    v_mfma_f32_32x32x16_bf16 v[144:159], v[200:203], v[124:127], v[144:159]
    ds_read_b128 v[196:199], v225 offset:8192
    s_waitcnt lgkmcnt(3)
    v_mfma_f32_32x32x16_bf16 v[160:175], v[204:207], v[96:99], 0
    ds_read_b128 v[200:203], v226 offset:8192
    s_waitcnt lgkmcnt(3)
    v_mfma_f32_32x32x16_bf16 v[160:175], v[208:211], v[100:103], v[160:175]
    ds_read_b128 v[204:207], v227 offset:8192
    s_waitcnt lgkmcnt(3)
    v_mfma_f32_32x32x16_bf16 v[160:175], v[192:195], v[104:107], v[160:175]
    ds_read_b128 v[208:211], v228 offset:8192
    s_waitcnt lgkmcnt(3)
    v_mfma_f32_32x32x16_bf16 v[160:175], v[196:199], v[108:111], v[160:175]
    ds_read_b128 v[192:195], v229 offset:8192
    s_waitcnt lgkmcnt(3)
    v_mfma_f32_32x32x16_bf16 v[160:175], v[200:203], v[112:115], v[160:175]
    ds_read_b128 v[196:199], v234 offset:0
    s_waitcnt lgkmcnt(3)
    v_mfma_f32_32x32x16_bf16 v[160:175], v[204:207], v[116:119], v[160:175]
    ds_read_b128 v[200:203], v247 offset:0
    s_waitcnt lgkmcnt(3)
    v_mfma_f32_32x32x16_bf16 v[160:175], v[208:211], v[120:123], v[160:175]
    ds_read_b128 v[204:207], v248 offset:0
    s_waitcnt lgkmcnt(3)
    v_mfma_f32_32x32x16_bf16 v[160:175], v[192:195], v[124:127], v[160:175]
    ds_read_b128 v[208:211], v249 offset:0
    s_waitcnt lgkmcnt(3)
    v_mfma_f32_16x16x32_bf16 v[216:219], v[196:199], v[128:131], 0
    s_waitcnt lgkmcnt(2)
    v_mfma_f32_16x16x32_bf16 v[216:219], v[200:203], v[132:135], v[216:219]
    s_waitcnt lgkmcnt(1)
    v_mfma_f32_16x16x32_bf16 v[216:219], v[204:207], v[136:139], v[216:219]
    s_waitcnt lgkmcnt(0)
    v_mfma_f32_16x16x32_bf16 v[216:219], v[208:211], v[140:143], v[216:219]
    s_nop 3
    v_max3_f32 v246, v144, v145, v146
    v_max3_f32 v247, v160, v161, v162
    v_max3_f32 v246, v246, v147, v148
    v_max3_f32 v247, v247, v163, v164
    v_max3_f32 v246, v246, v149, v150
    v_max3_f32 v247, v247, v165, v166
    v_max3_f32 v246, v246, v151, v152
    v_max3_f32 v247, v247, v167, v168
    v_max3_f32 v246, v246, v153, v154
    v_max3_f32 v247, v247, v169, v170
    v_max3_f32 v246, v246, v155, v156
    v_max3_f32 v247, v247, v171, v172
    v_max3_f32 v246, v246, v157, v158
    v_max3_f32 v247, v247, v173, v174
    v_max3_f32 v246, v246, v159, v175
    v_max_f32 v246, v246, v247
    v_max3_f32 v248, v216, v217, v218
    v_max_f32 v248, v248, v219
    v_mov_b32 v247, v246
    v_mov_b32 v249, v248
    s_nop 1
    v_permlane32_swap_b32 v246, v247
    v_permlane32_swap_b32 v248, v249
    s_nop 1
    v_max_f32 v246, v246, v247
    v_max_f32 v248, v248, v249
    v_mov_b32 v249, v248
    v_mul_f32 v246, s11, v246
    s_nop 1
    v_permlane16_swap_b32 v248, v249
    s_nop 1
    v_max_f32 v248, v248, v249
    v_mul_f32 v248, s11, v248
    v_add_f32 v250, s12, v242
    v_cmp_gt_f32 vcc, v246, v250
    s_nop 1
    s_cbranch_vccz L_nors_7
    v_max_f32 v250, v242, v246
    v_sub_f32 v251, v242, v250
    v_exp_f32 v251, v251
    v_mov_b32 v242, v250
    v_mul_f32 v243, v243, v251
    v_mul_f32 v0, v0, v251
    v_mul_f32 v1, v1, v251
    v_mul_f32 v2, v2, v251
    v_mul_f32 v3, v3, v251
    v_mul_f32 v4, v4, v251
    v_mul_f32 v5, v5, v251
    v_mul_f32 v6, v6, v251
    v_mul_f32 v7, v7, v251
    v_mul_f32 v8, v8, v251
    v_mul_f32 v9, v9, v251
    v_mul_f32 v10, v10, v251
    v_mul_f32 v11, v11, v251
    v_mul_f32 v12, v12, v251
    v_mul_f32 v13, v13, v251
    v_mul_f32 v14, v14, v251
    v_mul_f32 v15, v15, v251
    v_mul_f32 v16, v16, v251
    v_mul_f32 v17, v17, v251
    v_mul_f32 v18, v18, v251
    v_mul_f32 v19, v19, v251
    v_mul_f32 v20, v20, v251
    v_mul_f32 v21, v21, v251
    v_mul_f32 v22, v22, v251
    v_mul_f32 v23, v23, v251
    v_mul_f32 v24, v24, v251
    v_mul_f32 v25, v25, v251
    v_mul_f32 v26, v26, v251
    v_mul_f32 v27, v27, v251
    v_mul_f32 v28, v28, v251
    v_mul_f32 v29, v29, v251
    v_mul_f32 v30, v30, v251
    v_mul_f32 v31, v31, v251
    v_mul_f32 v32, v32, v251
    v_mul_f32 v33, v33, v251
    v_mul_f32 v34, v34, v251
    v_mul_f32 v35, v35, v251
    v_mul_f32 v36, v36, v251
    v_mul_f32 v37, v37, v251
    v_mul_f32 v38, v38, v251
    v_mul_f32 v39, v39, v251
    v_mul_f32 v40, v40, v251
    v_mul_f32 v41, v41, v251
    v_mul_f32 v42, v42, v251
    v_mul_f32 v43, v43, v251
    v_mul_f32 v44, v44, v251
    v_mul_f32 v45, v45, v251
    v_mul_f32 v46, v46, v251
    v_mul_f32 v47, v47, v251
    v_mul_f32 v48, v48, v251
    v_mul_f32 v49, v49, v251
    v_mul_f32 v50, v50, v251
    v_mul_f32 v51, v51, v251
    v_mul_f32 v52, v52, v251
    v_mul_f32 v53, v53, v251
    v_mul_f32 v54, v54, v251
    v_mul_f32 v55, v55, v251
    v_mul_f32 v56, v56, v251
    v_mul_f32 v57, v57, v251
    v_mul_f32 v58, v58, v251
    v_mul_f32 v59, v59, v251
    v_mul_f32 v60, v60, v251
    v_mul_f32 v61, v61, v251
    v_mul_f32 v62, v62, v251
    v_mul_f32 v63, v63, v251
L_nors_7:
    v_add_f32 v250, s12, v244
    v_cmp_gt_f32 vcc, v248, v250
    s_nop 1
    s_cbranch_vccz L_nors_8
    v_max_f32 v250, v244, v248
    v_sub_f32 v251, v244, v250
    v_exp_f32 v251, v251
    v_mov_b32 v244, v250
    v_mul_f32 v245, v245, v251
    v_mul_f32 v64, v64, v251
    v_mul_f32 v65, v65, v251
    v_mul_f32 v66, v66, v251
    v_mul_f32 v67, v67, v251
    v_mul_f32 v68, v68, v251
    v_mul_f32 v69, v69, v251
    v_mul_f32 v70, v70, v251
    v_mul_f32 v71, v71, v251
    v_mul_f32 v72, v72, v251
    v_mul_f32 v73, v73, v251
    v_mul_f32 v74, v74, v251
    v_mul_f32 v75, v75, v251
    v_mul_f32 v76, v76, v251
    v_mul_f32 v77, v77, v251
    v_mul_f32 v78, v78, v251
    v_mul_f32 v79, v79, v251
    v_mul_f32 v80, v80, v251
    v_mul_f32 v81, v81, v251
    v_mul_f32 v82, v82, v251
    v_mul_f32 v83, v83, v251
    v_mul_f32 v84, v84, v251
    v_mul_f32 v85, v85, v251
    v_mul_f32 v86, v86, v251
    v_mul_f32 v87, v87, v251
    v_mul_f32 v88, v88, v251
    v_mul_f32 v89, v89, v251
    v_mul_f32 v90, v90, v251
    v_mul_f32 v91, v91, v251
    v_mul_f32 v92, v92, v251
    v_mul_f32 v93, v93, v251
    v_mul_f32 v94, v94, v251
    v_mul_f32 v95, v95, v251
L_nors_8:
    v_fma_f32 v144, v144, s11, -v242
    v_fma_f32 v145, v145, s11, -v242
    v_fma_f32 v146, v146, s11, -v242
    v_fma_f32 v147, v147, s11, -v242
    v_fma_f32 v148, v148, s11, -v242
    v_fma_f32 v149, v149, s11, -v242
    v_fma_f32 v150, v150, s11, -v242
    v_fma_f32 v151, v151, s11, -v242
    v_fma_f32 v152, v152, s11, -v242
    v_fma_f32 v153, v153, s11, -v242
    v_fma_f32 v154, v154, s11, -v242
    v_fma_f32 v155, v155, s11, -v242
    v_fma_f32 v156, v156, s11, -v242
    v_fma_f32 v157, v157, s11, -v242
    v_fma_f32 v158, v158, s11, -v242
    v_fma_f32 v159, v159, s11, -v242
    v_fma_f32 v160, v160, s11, -v242
    v_fma_f32 v161, v161, s11, -v242
    v_fma_f32 v162, v162, s11, -v242
    v_fma_f32 v163, v163, s11, -v242
    v_fma_f32 v164, v164, s11, -v242
    v_fma_f32 v165, v165, s11, -v242
    v_fma_f32 v166, v166, s11, -v242
    v_fma_f32 v167, v167, s11, -v242
    v_fma_f32 v168, v168, s11, -v242
    v_fma_f32 v169, v169, s11, -v242
    v_fma_f32 v170, v170, s11, -v242
    v_fma_f32 v171, v171, s11, -v242
    v_fma_f32 v172, v172, s11, -v242
    v_fma_f32 v173, v173, s11, -v242
    v_fma_f32 v174, v174, s11, -v242
    v_fma_f32 v175, v175, s11, -v242
    v_fma_f32 v216, v216, s11, -v244
    v_fma_f32 v217, v217, s11, -v244
    v_fma_f32 v218, v218, s11, -v244
    v_fma_f32 v219, v219, s11, -v244
    v_exp_f32 v144, v144
    v_exp_f32 v145, v145
    v_exp_f32 v146, v146
    v_exp_f32 v147, v147
    v_exp_f32 v148, v148
    v_exp_f32 v149, v149
    v_exp_f32 v150, v150
    v_exp_f32 v151, v151
    v_exp_f32 v152, v152
    v_exp_f32 v153, v153
    v_exp_f32 v154, v154
    v_exp_f32 v155, v155
    v_exp_f32 v156, v156
    v_exp_f32 v157, v157
    v_exp_f32 v158, v158
    v_exp_f32 v159, v159
    v_exp_f32 v160, v160
    v_exp_f32 v161, v161
    v_exp_f32 v162, v162
    v_exp_f32 v163, v163
    v_exp_f32 v164, v164
    v_exp_f32 v165, v165
    v_exp_f32 v166, v166
    v_exp_f32 v167, v167
    v_exp_f32 v168, v168
    v_exp_f32 v169, v169
    v_exp_f32 v170, v170
    v_exp_f32 v171, v171
    v_exp_f32 v172, v172
    v_exp_f32 v173, v173
    v_exp_f32 v174, v174
    v_exp_f32 v175, v175
    v_exp_f32 v216, v216
    v_exp_f32 v217, v217
    v_exp_f32 v218, v218
    v_exp_f32 v219, v219
    v_add_f32 v246, v144, v145
    v_add_f32 v247, v146, v147
    v_add_f32 v246, v246, v148
    v_add_f32 v247, v247, v149
    v_add_f32 v246, v246, v150
    v_add_f32 v247, v247, v151
    v_add_f32 v246, v246, v152
    v_add_f32 v247, v247, v153
    v_add_f32 v246, v246, v154
    v_add_f32 v247, v247, v155
    v_add_f32 v246, v246, v156
    v_add_f32 v247, v247, v157
    v_add_f32 v246, v246, v158
    v_add_f32 v247, v247, v159
    v_add_f32 v246, v246, v160
    v_add_f32 v247, v247, v161
    v_add_f32 v246, v246, v162
    v_add_f32 v247, v247, v163
    v_add_f32 v246, v246, v164
    v_add_f32 v247, v247, v165
    v_add_f32 v246, v246, v166
    v_add_f32 v247, v247, v167
    v_add_f32 v246, v246, v168
    v_add_f32 v247, v247, v169
    v_add_f32 v246, v246, v170
    v_add_f32 v247, v247, v171
    v_add_f32 v246, v246, v172
    v_add_f32 v247, v247, v173
    v_add_f32 v246, v246, v174
    v_add_f32 v247, v247, v175
    v_cvt_pk_bf16_f32 v176, v144, v145
    v_cvt_pk_bf16_f32 v177, v146, v147
    v_cvt_pk_bf16_f32 v178, v148, v149
    v_cvt_pk_bf16_f32 v179, v150, v151
    v_cvt_pk_bf16_f32 v180, v152, v153
    v_cvt_pk_bf16_f32 v181, v154, v155
    v_cvt_pk_bf16_f32 v182, v156, v157
    v_cvt_pk_bf16_f32 v183, v158, v159
    v_cvt_pk_bf16_f32 v184, v160, v161
    v_cvt_pk_bf16_f32 v185, v162, v163
    v_cvt_pk_bf16_f32 v186, v164, v165
    v_cvt_pk_bf16_f32 v187, v166, v167
    v_cvt_pk_bf16_f32 v188, v168, v169
    v_cvt_pk_bf16_f32 v189, v170, v171
    v_cvt_pk_bf16_f32 v190, v172, v173
    v_cvt_pk_bf16_f32 v191, v174, v175
    v_add_f32 v248, v216, v217
    v_add_f32 v249, v218, v219
    v_cvt_pk_bf16_f32 v220, v216, v217
    v_cvt_pk_bf16_f32 v221, v218, v219
    v_add_f32 v246, v246, v247
    v_add_f32 v248, v248, v249
    v_add_f32 v243, v243, v246
    v_add_f32 v245, v245, v248
    s_cmp_eq_u32 s91, 1
    s_cbranch_scc1 L_k1_alax1
    s_waitcnt vmcnt(8)
L_k1_alax1:
    s_waitcnt vmcnt(13)
    s_barrier
    s_add_u32 s10, s7, s72
    s_and_b32 s10, s10, 0x1ffff
    s_and_b32 s13, s7, 0x20000
    s_add_u32 s10, s10, s13
    s_add_u32 s10, s10, s42
    s_cmp_lt_u32 s7, 0x40000
    s_cselect_b32 s10, s10, 0x7f000000
    s_add_u32 m0, s9, 0x0
    s_add_u32 s7, s7, 16384
    buffer_load_dwordx4 v237, s[48:51], s10 offen nt lds
    s_add_u32 m0, s9, 0x1000
    s_add_u32 s10, s10, 4096
    buffer_load_dwordx4 v237, s[48:51], s10 offen nt lds
    s_add_u32 m0, s9, 0x2000
    s_add_u32 s10, s10, 4096
    buffer_load_dwordx4 v237, s[48:51], s10 offen nt lds
    s_add_u32 m0, s9, 0x3000
    s_add_u32 s10, s10, 4096
    buffer_load_dwordx4 v237, s[48:51], s10 offen nt lds
    v_xor_b32 v247, 64, v235
    v_xor_b32 v248, 128, v235
    v_xor_b32 v249, 192, v235
    ds_read_b64_tr_b16 v[192:193], v230 offset:16384
    ds_read_b64_tr_b16 v[194:195], v230 offset:17408
    ds_read_b64_tr_b16 v[196:197], v231 offset:16384
    ds_read_b64_tr_b16 v[198:199], v231 offset:17408
    ds_read_b64_tr_b16 v[200:201], v232 offset:16384
    ds_read_b64_tr_b16 v[202:203], v232 offset:17408
    ds_read_b64_tr_b16 v[204:205], v233 offset:16384
    ds_read_b64_tr_b16 v[206:207], v233 offset:17408
    s_waitcnt lgkmcnt(6)
    v_mfma_f32_32x32x16_bf16 v[0:15], v[192:195], v[176:179], v[0:15]
    ds_read_b64_tr_b16 v[208:209], v235 offset:16384
    ds_read_b64_tr_b16 v[210:211], v235 offset:16392
    s_waitcnt lgkmcnt(6)
    v_mfma_f32_32x32x16_bf16 v[16:31], v[196:199], v[176:179], v[16:31]
    ds_read_b64_tr_b16 v[192:193], v230 offset:20480
    ds_read_b64_tr_b16 v[194:195], v230 offset:21504
    s_waitcnt lgkmcnt(6)
    v_mfma_f32_32x32x16_bf16 v[32:47], v[200:203], v[176:179], v[32:47]
    ds_read_b64_tr_b16 v[196:197], v231 offset:20480
    ds_read_b64_tr_b16 v[198:199], v231 offset:21504
    s_waitcnt lgkmcnt(6)
    v_mfma_f32_32x32x16_bf16 v[48:63], v[204:207], v[176:179], v[48:63]
    ds_read_b64_tr_b16 v[200:201], v232 offset:20480
    ds_read_b64_tr_b16 v[202:203], v232 offset:21504
    s_waitcnt lgkmcnt(6)
    v_mfma_f32_16x16x16_bf16 v[64:67], v[208:209], v[220:221], v[64:67]
    v_mfma_f32_16x16x16_bf16 v[68:71], v[210:211], v[220:221], v[68:71]
    ds_read_b64_tr_b16 v[204:205], v233 offset:20480
    ds_read_b64_tr_b16 v[206:207], v233 offset:21504
    s_waitcnt lgkmcnt(6)
    v_mfma_f32_32x32x16_bf16 v[0:15], v[192:195], v[180:183], v[0:15]
    ds_read_b64_tr_b16 v[208:209], v247 offset:16384
    ds_read_b64_tr_b16 v[210:211], v247 offset:16392
    s_waitcnt lgkmcnt(6)
    v_mfma_f32_32x32x16_bf16 v[16:31], v[196:199], v[180:183], v[16:31]
    ds_read_b64_tr_b16 v[192:193], v230 offset:24576
    ds_read_b64_tr_b16 v[194:195], v230 offset:25600
    s_waitcnt lgkmcnt(6)
    v_mfma_f32_32x32x16_bf16 v[32:47], v[200:203], v[180:183], v[32:47]
    ds_read_b64_tr_b16 v[196:197], v231 offset:24576
    ds_read_b64_tr_b16 v[198:199], v231 offset:25600
    s_waitcnt lgkmcnt(6)
    v_mfma_f32_32x32x16_bf16 v[48:63], v[204:207], v[180:183], v[48:63]
    ds_read_b64_tr_b16 v[200:201], v232 offset:24576
    ds_read_b64_tr_b16 v[202:203], v232 offset:25600
    s_waitcnt lgkmcnt(6)
    v_mfma_f32_16x16x16_bf16 v[72:75], v[208:209], v[220:221], v[72:75]
    v_mfma_f32_16x16x16_bf16 v[76:79], v[210:211], v[220:221], v[76:79]
    ds_read_b64_tr_b16 v[204:205], v233 offset:24576
    ds_read_b64_tr_b16 v[206:207], v233 offset:25600
    s_waitcnt lgkmcnt(6)
    v_mfma_f32_32x32x16_bf16 v[0:15], v[192:195], v[184:187], v[0:15]
    ds_read_b64_tr_b16 v[208:209], v248 offset:16384
    ds_read_b64_tr_b16 v[210:211], v248 offset:16392
    s_waitcnt lgkmcnt(6)
    v_mfma_f32_32x32x16_bf16 v[16:31], v[196:199], v[184:187], v[16:31]
    ds_read_b64_tr_b16 v[192:193], v230 offset:28672
    ds_read_b64_tr_b16 v[194:195], v230 offset:29696
    s_waitcnt lgkmcnt(6)
    v_mfma_f32_32x32x16_bf16 v[32:47], v[200:203], v[184:187], v[32:47]
    ds_read_b64_tr_b16 v[196:197], v231 offset:28672
    ds_read_b64_tr_b16 v[198:199], v231 offset:29696
    s_waitcnt lgkmcnt(6)
    v_mfma_f32_32x32x16_bf16 v[48:63], v[204:207], v[184:187], v[48:63]
    ds_read_b64_tr_b16 v[200:201], v232 offset:28672
    ds_read_b64_tr_b16 v[202:203], v232 offset:29696
    s_waitcnt lgkmcnt(6)
    v_mfma_f32_16x16x16_bf16 v[80:83], v[208:209], v[220:221], v[80:83]
    v_mfma_f32_16x16x16_bf16 v[84:87], v[210:211], v[220:221], v[84:87]
    ds_read_b64_tr_b16 v[204:205], v233 offset:28672
    ds_read_b64_tr_b16 v[206:207], v233 offset:29696
    s_waitcnt lgkmcnt(6)
    v_mfma_f32_32x32x16_bf16 v[0:15], v[192:195], v[188:191], v[0:15]
    ds_read_b64_tr_b16 v[208:209], v249 offset:16384
    ds_read_b64_tr_b16 v[210:211], v249 offset:16392
    s_waitcnt lgkmcnt(6)
    v_mfma_f32_32x32x16_bf16 v[16:31], v[196:199], v[188:191], v[16:31]
    s_waitcnt lgkmcnt(4)
    v_mfma_f32_32x32x16_bf16 v[32:47], v[200:203], v[188:191], v[32:47]
    s_waitcnt lgkmcnt(2)
    v_mfma_f32_32x32x16_bf16 v[48:63], v[204:207], v[188:191], v[48:63]
    s_waitcnt lgkmcnt(0)
    v_mfma_f32_16x16x16_bf16 v[88:91], v[208:209], v[220:221], v[88:91]
    v_mfma_f32_16x16x16_bf16 v[92:95], v[210:211], v[220:221], v[92:95]
    s_cmp_eq_u32 s91, 1
    s_cbranch_scc1 L_k1_alax2
    s_waitcnt vmcnt(8)
L_k1_alax2:
    s_waitcnt vmcnt(13)
    s_barrier
    s_add_u32 s10, s8, s72
    s_and_b32 s10, s10, 0x1ffff
    s_and_b32 s13, s8, 0x20000
    s_add_u32 s10, s10, s13
    s_add_u32 s10, s10, s42
    s_cmp_lt_u32 s8, 0x40000
    s_cselect_b32 s10, s10, 0x7f000000
    s_add_u32 m0, s9, 0x4000
    s_add_u32 s8, s8, 16384
    buffer_load_dwordx4 v238, s[52:55], s10 offen nt lds
    s_add_u32 m0, s9, 0x5000
    s_add_u32 s10, s10, 4096
    buffer_load_dwordx4 v238, s[52:55], s10 offen nt lds
    s_add_u32 m0, s9, 0x6000
    s_add_u32 s10, s10, 4096
    buffer_load_dwordx4 v238, s[52:55], s10 offen nt lds
    s_add_u32 m0, s9, 0x7000
    s_add_u32 s10, s10, 4096
    buffer_load_dwordx4 v238, s[52:55], s10 offen nt lds
    v_xor_b32 v247, 64, v234
    v_xor_b32 v248, 128, v234
    v_xor_b32 v249, 192, v234
    ds_read_b128 v[192:195], v222 offset:32768
    ds_read_b128 v[196:199], v223 offset:32768
    ds_read_b128 v[200:203], v224 offset:32768
    ds_read_b128 v[204:207], v225 offset:32768
    s_waitcnt lgkmcnt(3)
    v_mfma_f32_32x32x16_bf16 v[144:159], v[192:195], v[96:99], 0
    ds_read_b128 v[208:211], v226 offset:32768
    s_waitcnt lgkmcnt(3)
    v_mfma_f32_32x32x16_bf16 v[144:159], v[196:199], v[100:103], v[144:159]
    ds_read_b128 v[192:195], v227 offset:32768
    s_waitcnt lgkmcnt(3)
    v_mfma_f32_32x32x16_bf16 v[144:159], v[200:203], v[104:107], v[144:159]
    ds_read_b128 v[196:199], v228 offset:32768
    s_waitcnt lgkmcnt(3)
    v_mfma_f32_32x32x16_bf16 v[144:159], v[204:207], v[108:111], v[144:159]
    ds_read_b128 v[200:203], v229 offset:32768
    s_waitcnt lgkmcnt(3)
    v_mfma_f32_32x32x16_bf16 v[144:159], v[208:211], v[112:115], v[144:159]
    ds_read_b128 v[204:207], v222 offset:40960
    s_waitcnt lgkmcnt(3)
    v_mfma_f32_32x32x16_bf16 v[144:159], v[192:195], v[116:119], v[144:159]
    ds_read_b128 v[208:211], v223 offset:40960
    s_waitcnt lgkmcnt(3)
    v_mfma_f32_32x32x16_bf16 v[144:159], v[196:199], v[120:123], v[144:159]
    ds_read_b128 v[192:195], v224 offset:40960
    s_waitcnt lgkmcnt(3)
    v_mfma_f32_32x32x16_bf16 v[144:159], v[200:203], v[124:127], v[144:159]
    ds_read_b128 v[196:199], v225 offset:40960
    s_waitcnt lgkmcnt(3)
    v_mfma_f32_32x32x16_bf16 v[160:175], v[204:207], v[96:99], 0
    ds_read_b128 v[200:203], v226 offset:40960
    s_waitcnt lgkmcnt(3)
    v_mfma_f32_32x32x16_bf16 v[160:175], v[208:211], v[100:103], v[160:175]
    ds_read_b128 v[204:207], v227 offset:40960
    s_waitcnt lgkmcnt(3)
    v_mfma_f32_32x32x16_bf16 v[160:175], v[192:195], v[104:107], v[160:175]
    ds_read_b128 v[208:211], v228 offset:40960
    s_waitcnt lgkmcnt(3)
    v_mfma_f32_32x32x16_bf16 v[160:175], v[196:199], v[108:111], v[160:175]
    ds_read_b128 v[192:195], v229 offset:40960
    s_waitcnt lgkmcnt(3)
    v_mfma_f32_32x32x16_bf16 v[160:175], v[200:203], v[112:115], v[160:175]
    ds_read_b128 v[196:199], v234 offset:32768
    s_waitcnt lgkmcnt(3)
    v_mfma_f32_32x32x16_bf16 v[160:175], v[204:207], v[116:119], v[160:175]
    ds_read_b128 v[200:203], v247 offset:32768
    s_waitcnt lgkmcnt(3)
    v_mfma_f32_32x32x16_bf16 v[160:175], v[208:211], v[120:123], v[160:175]
    ds_read_b128 v[204:207], v248 offset:32768
    s_waitcnt lgkmcnt(3)
    v_mfma_f32_32x32x16_bf16 v[160:175], v[192:195], v[124:127], v[160:175]
    ds_read_b128 v[208:211], v249 offset:32768
    s_waitcnt lgkmcnt(3)
    v_mfma_f32_16x16x32_bf16 v[216:219], v[196:199], v[128:131], 0
    s_waitcnt lgkmcnt(2)
    v_mfma_f32_16x16x32_bf16 v[216:219], v[200:203], v[132:135], v[216:219]
    s_waitcnt lgkmcnt(1)
    v_mfma_f32_16x16x32_bf16 v[216:219], v[204:207], v[136:139], v[216:219]
    s_waitcnt lgkmcnt(0)
    v_mfma_f32_16x16x32_bf16 v[216:219], v[208:211], v[140:143], v[216:219]
    s_nop 3
    v_max3_f32 v246, v144, v145, v146
    v_max3_f32 v247, v160, v161, v162
    v_max3_f32 v246, v246, v147, v148
    v_max3_f32 v247, v247, v163, v164
    v_max3_f32 v246, v246, v149, v150
    v_max3_f32 v247, v247, v165, v166
    v_max3_f32 v246, v246, v151, v152
    v_max3_f32 v247, v247, v167, v168
    v_max3_f32 v246, v246, v153, v154
    v_max3_f32 v247, v247, v169, v170
    v_max3_f32 v246, v246, v155, v156
    v_max3_f32 v247, v247, v171, v172
    v_max3_f32 v246, v246, v157, v158
    v_max3_f32 v247, v247, v173, v174
    v_max3_f32 v246, v246, v159, v175
    v_max_f32 v246, v246, v247
    v_max3_f32 v248, v216, v217, v218
    v_max_f32 v248, v248, v219
    v_mov_b32 v247, v246
    v_mov_b32 v249, v248
    s_nop 1
    v_permlane32_swap_b32 v246, v247
    v_permlane32_swap_b32 v248, v249
    s_nop 1
    v_max_f32 v246, v246, v247
    v_max_f32 v248, v248, v249
    v_mov_b32 v249, v248
    v_mul_f32 v246, s11, v246
    s_nop 1
    v_permlane16_swap_b32 v248, v249
    s_nop 1
    v_max_f32 v248, v248, v249
    v_mul_f32 v248, s11, v248
    v_add_f32 v250, s12, v242
    v_cmp_gt_f32 vcc, v246, v250
    s_nop 1
    s_cbranch_vccz L_nors_9
    v_max_f32 v250, v242, v246
    v_sub_f32 v251, v242, v250
    v_exp_f32 v251, v251
    v_mov_b32 v242, v250
    v_mul_f32 v243, v243, v251
    v_mul_f32 v0, v0, v251
    v_mul_f32 v1, v1, v251
    v_mul_f32 v2, v2, v251
    v_mul_f32 v3, v3, v251
    v_mul_f32 v4, v4, v251
    v_mul_f32 v5, v5, v251
    v_mul_f32 v6, v6, v251
    v_mul_f32 v7, v7, v251
    v_mul_f32 v8, v8, v251
    v_mul_f32 v9, v9, v251
    v_mul_f32 v10, v10, v251
    v_mul_f32 v11, v11, v251
    v_mul_f32 v12, v12, v251
    v_mul_f32 v13, v13, v251
    v_mul_f32 v14, v14, v251
    v_mul_f32 v15, v15, v251
    v_mul_f32 v16, v16, v251
    v_mul_f32 v17, v17, v251
    v_mul_f32 v18, v18, v251
    v_mul_f32 v19, v19, v251
    v_mul_f32 v20, v20, v251
    v_mul_f32 v21, v21, v251
    v_mul_f32 v22, v22, v251
    v_mul_f32 v23, v23, v251
    v_mul_f32 v24, v24, v251
    v_mul_f32 v25, v25, v251
    v_mul_f32 v26, v26, v251
    v_mul_f32 v27, v27, v251
    v_mul_f32 v28, v28, v251
    v_mul_f32 v29, v29, v251
    v_mul_f32 v30, v30, v251
    v_mul_f32 v31, v31, v251
    v_mul_f32 v32, v32, v251
    v_mul_f32 v33, v33, v251
    v_mul_f32 v34, v34, v251
    v_mul_f32 v35, v35, v251
    v_mul_f32 v36, v36, v251
    v_mul_f32 v37, v37, v251
    v_mul_f32 v38, v38, v251
    v_mul_f32 v39, v39, v251
    v_mul_f32 v40, v40, v251
    v_mul_f32 v41, v41, v251
    v_mul_f32 v42, v42, v251
    v_mul_f32 v43, v43, v251
    v_mul_f32 v44, v44, v251
    v_mul_f32 v45, v45, v251
    v_mul_f32 v46, v46, v251
    v_mul_f32 v47, v47, v251
    v_mul_f32 v48, v48, v251
    v_mul_f32 v49, v49, v251
    v_mul_f32 v50, v50, v251
    v_mul_f32 v51, v51, v251
    v_mul_f32 v52, v52, v251
    v_mul_f32 v53, v53, v251
    v_mul_f32 v54, v54, v251
    v_mul_f32 v55, v55, v251
    v_mul_f32 v56, v56, v251
    v_mul_f32 v57, v57, v251
    v_mul_f32 v58, v58, v251
    v_mul_f32 v59, v59, v251
    v_mul_f32 v60, v60, v251
    v_mul_f32 v61, v61, v251
    v_mul_f32 v62, v62, v251
    v_mul_f32 v63, v63, v251
L_nors_9:
    v_add_f32 v250, s12, v244
    v_cmp_gt_f32 vcc, v248, v250
    s_nop 1
    s_cbranch_vccz L_nors_10
    v_max_f32 v250, v244, v248
    v_sub_f32 v251, v244, v250
    v_exp_f32 v251, v251
    v_mov_b32 v244, v250
    v_mul_f32 v245, v245, v251
    v_mul_f32 v64, v64, v251
    v_mul_f32 v65, v65, v251
    v_mul_f32 v66, v66, v251
    v_mul_f32 v67, v67, v251
    v_mul_f32 v68, v68, v251
    v_mul_f32 v69, v69, v251
    v_mul_f32 v70, v70, v251
    v_mul_f32 v71, v71, v251
    v_mul_f32 v72, v72, v251
    v_mul_f32 v73, v73, v251
    v_mul_f32 v74, v74, v251
    v_mul_f32 v75, v75, v251
    v_mul_f32 v76, v76, v251
    v_mul_f32 v77, v77, v251
    v_mul_f32 v78, v78, v251
    v_mul_f32 v79, v79, v251
    v_mul_f32 v80, v80, v251
    v_mul_f32 v81, v81, v251
    v_mul_f32 v82, v82, v251
    v_mul_f32 v83, v83, v251
    v_mul_f32 v84, v84, v251
    v_mul_f32 v85, v85, v251
    v_mul_f32 v86, v86, v251
    v_mul_f32 v87, v87, v251
    v_mul_f32 v88, v88, v251
    v_mul_f32 v89, v89, v251
    v_mul_f32 v90, v90, v251
    v_mul_f32 v91, v91, v251
    v_mul_f32 v92, v92, v251
    v_mul_f32 v93, v93, v251
    v_mul_f32 v94, v94, v251
    v_mul_f32 v95, v95, v251
L_nors_10:
    v_fma_f32 v144, v144, s11, -v242
    v_fma_f32 v145, v145, s11, -v242
    v_fma_f32 v146, v146, s11, -v242
    v_fma_f32 v147, v147, s11, -v242
    v_fma_f32 v148, v148, s11, -v242
    v_fma_f32 v149, v149, s11, -v242
    v_fma_f32 v150, v150, s11, -v242
    v_fma_f32 v151, v151, s11, -v242
    v_fma_f32 v152, v152, s11, -v242
    v_fma_f32 v153, v153, s11, -v242
    v_fma_f32 v154, v154, s11, -v242
    v_fma_f32 v155, v155, s11, -v242
    v_fma_f32 v156, v156, s11, -v242
    v_fma_f32 v157, v157, s11, -v242
    v_fma_f32 v158, v158, s11, -v242
    v_fma_f32 v159, v159, s11, -v242
    v_fma_f32 v160, v160, s11, -v242
    v_fma_f32 v161, v161, s11, -v242
    v_fma_f32 v162, v162, s11, -v242
    v_fma_f32 v163, v163, s11, -v242
    v_fma_f32 v164, v164, s11, -v242
    v_fma_f32 v165, v165, s11, -v242
    v_fma_f32 v166, v166, s11, -v242
    v_fma_f32 v167, v167, s11, -v242
    v_fma_f32 v168, v168, s11, -v242
    v_fma_f32 v169, v169, s11, -v242
    v_fma_f32 v170, v170, s11, -v242
    v_fma_f32 v171, v171, s11, -v242
    v_fma_f32 v172, v172, s11, -v242
    v_fma_f32 v173, v173, s11, -v242
    v_fma_f32 v174, v174, s11, -v242
    v_fma_f32 v175, v175, s11, -v242
    v_fma_f32 v216, v216, s11, -v244
    v_fma_f32 v217, v217, s11, -v244
    v_fma_f32 v218, v218, s11, -v244
    v_fma_f32 v219, v219, s11, -v244
    v_exp_f32 v144, v144
    v_exp_f32 v145, v145
    v_exp_f32 v146, v146
    v_exp_f32 v147, v147
    v_exp_f32 v148, v148
    v_exp_f32 v149, v149
    v_exp_f32 v150, v150
    v_exp_f32 v151, v151
    v_exp_f32 v152, v152
    v_exp_f32 v153, v153
    v_exp_f32 v154, v154
    v_exp_f32 v155, v155
    v_exp_f32 v156, v156
    v_exp_f32 v157, v157
    v_exp_f32 v158, v158
    v_exp_f32 v159, v159
    v_exp_f32 v160, v160
    v_exp_f32 v161, v161
    v_exp_f32 v162, v162
    v_exp_f32 v163, v163
    v_exp_f32 v164, v164
    v_exp_f32 v165, v165
    v_exp_f32 v166, v166
    v_exp_f32 v167, v167
    v_exp_f32 v168, v168
    v_exp_f32 v169, v169
    v_exp_f32 v170, v170
    v_exp_f32 v171, v171
    v_exp_f32 v172, v172
    v_exp_f32 v173, v173
    v_exp_f32 v174, v174
    v_exp_f32 v175, v175
    v_exp_f32 v216, v216
    v_exp_f32 v217, v217
    v_exp_f32 v218, v218
    v_exp_f32 v219, v219
    v_add_f32 v246, v144, v145
    v_add_f32 v247, v146, v147
    v_add_f32 v246, v246, v148
    v_add_f32 v247, v247, v149
    v_add_f32 v246, v246, v150
    v_add_f32 v247, v247, v151
    v_add_f32 v246, v246, v152
    v_add_f32 v247, v247, v153
    v_add_f32 v246, v246, v154
    v_add_f32 v247, v247, v155
    v_add_f32 v246, v246, v156
    v_add_f32 v247, v247, v157
    v_add_f32 v246, v246, v158
    v_add_f32 v247, v247, v159
    v_add_f32 v246, v246, v160
    v_add_f32 v247, v247, v161
    v_add_f32 v246, v246, v162
    v_add_f32 v247, v247, v163
    v_add_f32 v246, v246, v164
    v_add_f32 v247, v247, v165
    v_add_f32 v246, v246, v166
    v_add_f32 v247, v247, v167
    v_add_f32 v246, v246, v168
    v_add_f32 v247, v247, v169
    v_add_f32 v246, v246, v170
    v_add_f32 v247, v247, v171
    v_add_f32 v246, v246, v172
    v_add_f32 v247, v247, v173
    v_add_f32 v246, v246, v174
    v_add_f32 v247, v247, v175
    v_cvt_pk_bf16_f32 v176, v144, v145
    v_cvt_pk_bf16_f32 v177, v146, v147
    v_cvt_pk_bf16_f32 v178, v148, v149
    v_cvt_pk_bf16_f32 v179, v150, v151
    v_cvt_pk_bf16_f32 v180, v152, v153
    v_cvt_pk_bf16_f32 v181, v154, v155
    v_cvt_pk_bf16_f32 v182, v156, v157
    v_cvt_pk_bf16_f32 v183, v158, v159
    v_cvt_pk_bf16_f32 v184, v160, v161
    v_cvt_pk_bf16_f32 v185, v162, v163
    v_cvt_pk_bf16_f32 v186, v164, v165
    v_cvt_pk_bf16_f32 v187, v166, v167
    v_cvt_pk_bf16_f32 v188, v168, v169
    v_cvt_pk_bf16_f32 v189, v170, v171
    v_cvt_pk_bf16_f32 v190, v172, v173
    v_cvt_pk_bf16_f32 v191, v174, v175
    v_add_f32 v248, v216, v217
    v_add_f32 v249, v218, v219
    v_cvt_pk_bf16_f32 v220, v216, v217
    v_cvt_pk_bf16_f32 v221, v218, v219
    v_add_f32 v246, v246, v247
    v_add_f32 v248, v248, v249
    v_add_f32 v243, v243, v246
    v_add_f32 v245, v245, v248
    s_mov_b32 s91, 0
    s_waitcnt vmcnt(8)
    s_barrier
    s_add_u32 s10, s7, s72
    s_and_b32 s10, s10, 0x1ffff
    s_and_b32 s13, s7, 0x20000
    s_add_u32 s10, s10, s13
    s_add_u32 s10, s10, s42
    s_cmp_lt_u32 s7, 0x40000
    s_cselect_b32 s10, s10, 0x7f000000
    s_add_u32 m0, s9, 0x8000
    s_add_u32 s7, s7, 16384
    buffer_load_dwordx4 v237, s[48:51], s10 offen nt lds
    s_add_u32 m0, s9, 0x9000
    s_add_u32 s10, s10, 4096
    buffer_load_dwordx4 v237, s[48:51], s10 offen nt lds
    s_add_u32 m0, s9, 0xa000
    s_add_u32 s10, s10, 4096
    buffer_load_dwordx4 v237, s[48:51], s10 offen nt lds
    s_add_u32 m0, s9, 0xb000
    s_add_u32 s10, s10, 4096
    buffer_load_dwordx4 v237, s[48:51], s10 offen nt lds
    v_xor_b32 v247, 64, v235
    v_xor_b32 v248, 128, v235
    v_xor_b32 v249, 192, v235
    ds_read_b64_tr_b16 v[192:193], v230 offset:49152
    ds_read_b64_tr_b16 v[194:195], v230 offset:50176
    ds_read_b64_tr_b16 v[196:197], v231 offset:49152
    ds_read_b64_tr_b16 v[198:199], v231 offset:50176
    ds_read_b64_tr_b16 v[200:201], v232 offset:49152
    ds_read_b64_tr_b16 v[202:203], v232 offset:50176
    ds_read_b64_tr_b16 v[204:205], v233 offset:49152
    ds_read_b64_tr_b16 v[206:207], v233 offset:50176
    s_waitcnt lgkmcnt(6)
    v_mfma_f32_32x32x16_bf16 v[0:15], v[192:195], v[176:179], v[0:15]
    ds_read_b64_tr_b16 v[208:209], v235 offset:49152
    ds_read_b64_tr_b16 v[210:211], v235 offset:49160
    s_waitcnt lgkmcnt(6)
    v_mfma_f32_32x32x16_bf16 v[16:31], v[196:199], v[176:179], v[16:31]
    ds_read_b64_tr_b16 v[192:193], v230 offset:53248
    ds_read_b64_tr_b16 v[194:195], v230 offset:54272
    s_waitcnt lgkmcnt(6)
    v_mfma_f32_32x32x16_bf16 v[32:47], v[200:203], v[176:179], v[32:47]
    ds_read_b64_tr_b16 v[196:197], v231 offset:53248
    ds_read_b64_tr_b16 v[198:199], v231 offset:54272
    s_waitcnt lgkmcnt(6)
    v_mfma_f32_32x32x16_bf16 v[48:63], v[204:207], v[176:179], v[48:63]
    ds_read_b64_tr_b16 v[200:201], v232 offset:53248
    ds_read_b64_tr_b16 v[202:203], v232 offset:54272
    s_waitcnt lgkmcnt(6)
    v_mfma_f32_16x16x16_bf16 v[64:67], v[208:209], v[220:221], v[64:67]
    v_mfma_f32_16x16x16_bf16 v[68:71], v[210:211], v[220:221], v[68:71]
    ds_read_b64_tr_b16 v[204:205], v233 offset:53248
    ds_read_b64_tr_b16 v[206:207], v233 offset:54272
    s_waitcnt lgkmcnt(6)
    v_mfma_f32_32x32x16_bf16 v[0:15], v[192:195], v[180:183], v[0:15]
    ds_read_b64_tr_b16 v[208:209], v247 offset:49152
    ds_read_b64_tr_b16 v[210:211], v247 offset:49160
    s_waitcnt lgkmcnt(6)
    v_mfma_f32_32x32x16_bf16 v[16:31], v[196:199], v[180:183], v[16:31]
    ds_read_b64_tr_b16 v[192:193], v230 offset:57344
    ds_read_b64_tr_b16 v[194:195], v230 offset:58368
    s_waitcnt lgkmcnt(6)
    v_mfma_f32_32x32x16_bf16 v[32:47], v[200:203], v[180:183], v[32:47]
    ds_read_b64_tr_b16 v[196:197], v231 offset:57344
    ds_read_b64_tr_b16 v[198:199], v231 offset:58368
    s_waitcnt lgkmcnt(6)
    v_mfma_f32_32x32x16_bf16 v[48:63], v[204:207], v[180:183], v[48:63]
    ds_read_b64_tr_b16 v[200:201], v232 offset:57344
    ds_read_b64_tr_b16 v[202:203], v232 offset:58368
    s_waitcnt lgkmcnt(6)
    v_mfma_f32_16x16x16_bf16 v[72:75], v[208:209], v[220:221], v[72:75]
    v_mfma_f32_16x16x16_bf16 v[76:79], v[210:211], v[220:221], v[76:79]
    ds_read_b64_tr_b16 v[204:205], v233 offset:57344
    ds_read_b64_tr_b16 v[206:207], v233 offset:58368
    s_waitcnt lgkmcnt(6)
    v_mfma_f32_32x32x16_bf16 v[0:15], v[192:195], v[184:187], v[0:15]
    ds_read_b64_tr_b16 v[208:209], v248 offset:49152
    ds_read_b64_tr_b16 v[210:211], v248 offset:49160
    s_waitcnt lgkmcnt(6)
    v_mfma_f32_32x32x16_bf16 v[16:31], v[196:199], v[184:187], v[16:31]
    ds_read_b64_tr_b16 v[192:193], v230 offset:61440
    ds_read_b64_tr_b16 v[194:195], v230 offset:62464
    s_waitcnt lgkmcnt(6)
    v_mfma_f32_32x32x16_bf16 v[32:47], v[200:203], v[184:187], v[32:47]
    ds_read_b64_tr_b16 v[196:197], v231 offset:61440
    ds_read_b64_tr_b16 v[198:199], v231 offset:62464
    s_waitcnt lgkmcnt(6)
    v_mfma_f32_32x32x16_bf16 v[48:63], v[204:207], v[184:187], v[48:63]
    ds_read_b64_tr_b16 v[200:201], v232 offset:61440
    ds_read_b64_tr_b16 v[202:203], v232 offset:62464
    s_waitcnt lgkmcnt(6)
    v_mfma_f32_16x16x16_bf16 v[80:83], v[208:209], v[220:221], v[80:83]
    v_mfma_f32_16x16x16_bf16 v[84:87], v[210:211], v[220:221], v[84:87]
    ds_read_b64_tr_b16 v[204:205], v233 offset:61440
    ds_read_b64_tr_b16 v[206:207], v233 offset:62464
    s_waitcnt lgkmcnt(6)
    v_mfma_f32_32x32x16_bf16 v[0:15], v[192:195], v[188:191], v[0:15]
    ds_read_b64_tr_b16 v[208:209], v249 offset:49152
    ds_read_b64_tr_b16 v[210:211], v249 offset:49160
    s_waitcnt lgkmcnt(6)
    v_mfma_f32_32x32x16_bf16 v[16:31], v[196:199], v[188:191], v[16:31]
    s_waitcnt lgkmcnt(4)
    v_mfma_f32_32x32x16_bf16 v[32:47], v[200:203], v[188:191], v[32:47]
    s_waitcnt lgkmcnt(2)
    v_mfma_f32_32x32x16_bf16 v[48:63], v[204:207], v[188:191], v[48:63]
    s_waitcnt lgkmcnt(0)
    v_mfma_f32_16x16x16_bf16 v[88:91], v[208:209], v[220:221], v[88:91]
    v_mfma_f32_16x16x16_bf16 v[92:95], v[210:211], v[220:221], v[92:95]
    s_add_u32 s27, s27, 1
    s_cmp_lt_u32 s27, 3
    s_cbranch_scc1 L_k1_blk
    s_waitcnt vmcnt(8)
    s_barrier
    s_add_u32 s10, s8, s72
    s_and_b32 s10, s10, 0x1ffff
    s_and_b32 s13, s8, 0x20000
    s_add_u32 s10, s10, s13
    s_add_u32 s10, s10, s42
    s_cmp_lt_u32 s8, 0x40000
    s_cselect_b32 s10, s10, 0x7f000000
    s_add_u32 m0, s9, 0xc000
    s_add_u32 s8, s8, 16384
    buffer_load_dwordx4 v238, s[52:55], s10 offen nt lds
    s_add_u32 m0, s9, 0xd000
    s_add_u32 s10, s10, 4096
    buffer_load_dwordx4 v238, s[52:55], s10 offen nt lds
    s_add_u32 m0, s9, 0xe000
    s_add_u32 s10, s10, 4096
    buffer_load_dwordx4 v238, s[52:55], s10 offen nt lds
    s_add_u32 m0, s9, 0xf000
    s_add_u32 s10, s10, 4096
    buffer_load_dwordx4 v238, s[52:55], s10 offen nt lds
    v_xor_b32 v247, 64, v234
    v_xor_b32 v248, 128, v234
    v_xor_b32 v249, 192, v234
    ds_read_b128 v[192:195], v222 offset:0
    ds_read_b128 v[196:199], v223 offset:0
    ds_read_b128 v[200:203], v224 offset:0
    ds_read_b128 v[204:207], v225 offset:0
    s_waitcnt lgkmcnt(3)
    v_mfma_f32_32x32x16_bf16 v[144:159], v[192:195], v[96:99], 0
    ds_read_b128 v[208:211], v226 offset:0
    s_waitcnt lgkmcnt(3)
    v_mfma_f32_32x32x16_bf16 v[144:159], v[196:199], v[100:103], v[144:159]
    ds_read_b128 v[192:195], v227 offset:0
    s_waitcnt lgkmcnt(3)
    v_mfma_f32_32x32x16_bf16 v[144:159], v[200:203], v[104:107], v[144:159]
    ds_read_b128 v[196:199], v228 offset:0
    s_waitcnt lgkmcnt(3)
    v_mfma_f32_32x32x16_bf16 v[144:159], v[204:207], v[108:111], v[144:159]
    ds_read_b128 v[200:203], v229 offset:0
    s_waitcnt lgkmcnt(3)
    v_mfma_f32_32x32x16_bf16 v[144:159], v[208:211], v[112:115], v[144:159]
    ds_read_b128 v[204:207], v222 offset:8192
    s_waitcnt lgkmcnt(3)
    v_mfma_f32_32x32x16_bf16 v[144:159], v[192:195], v[116:119], v[144:159]
    ds_read_b128 v[208:211], v223 offset:8192
    s_waitcnt lgkmcnt(3)
    v_mfma_f32_32x32x16_bf16 v[144:159], v[196:199], v[120:123], v[144:159]
    ds_read_b128 v[192:195], v224 offset:8192
    s_waitcnt lgkmcnt(3)
    v_mfma_f32_32x32x16_bf16 v[144:159], v[200:203], v[124:127], v[144:159]
    ds_read_b128 v[196:199], v225 offset:8192
    s_waitcnt lgkmcnt(3)
    v_mfma_f32_32x32x16_bf16 v[160:175], v[204:207], v[96:99], 0
    ds_read_b128 v[200:203], v226 offset:8192
    s_waitcnt lgkmcnt(3)
    v_mfma_f32_32x32x16_bf16 v[160:175], v[208:211], v[100:103], v[160:175]
    ds_read_b128 v[204:207], v227 offset:8192
    s_waitcnt lgkmcnt(3)
    v_mfma_f32_32x32x16_bf16 v[160:175], v[192:195], v[104:107], v[160:175]
    ds_read_b128 v[208:211], v228 offset:8192
    s_waitcnt lgkmcnt(3)
    v_mfma_f32_32x32x16_bf16 v[160:175], v[196:199], v[108:111], v[160:175]
    ds_read_b128 v[192:195], v229 offset:8192
    s_waitcnt lgkmcnt(3)
    v_mfma_f32_32x32x16_bf16 v[160:175], v[200:203], v[112:115], v[160:175]
    ds_read_b128 v[196:199], v234 offset:0
    s_waitcnt lgkmcnt(3)
    v_mfma_f32_32x32x16_bf16 v[160:175], v[204:207], v[116:119], v[160:175]
    ds_read_b128 v[200:203], v247 offset:0
    s_waitcnt lgkmcnt(3)
    v_mfma_f32_32x32x16_bf16 v[160:175], v[208:211], v[120:123], v[160:175]
    ds_read_b128 v[204:207], v248 offset:0
    s_waitcnt lgkmcnt(3)
    v_mfma_f32_32x32x16_bf16 v[160:175], v[192:195], v[124:127], v[160:175]
    ds_read_b128 v[208:211], v249 offset:0
    s_waitcnt lgkmcnt(3)
    v_mfma_f32_16x16x32_bf16 v[216:219], v[196:199], v[128:131], 0
    s_waitcnt lgkmcnt(2)
    v_mfma_f32_16x16x32_bf16 v[216:219], v[200:203], v[132:135], v[216:219]
    s_waitcnt lgkmcnt(1)
    v_mfma_f32_16x16x32_bf16 v[216:219], v[204:207], v[136:139], v[216:219]
    s_waitcnt lgkmcnt(0)
    v_mfma_f32_16x16x32_bf16 v[216:219], v[208:211], v[140:143], v[216:219]
    s_nop 3
    v_max3_f32 v246, v144, v145, v146
    v_max3_f32 v247, v160, v161, v162
    v_max3_f32 v246, v246, v147, v148
    v_max3_f32 v247, v247, v163, v164
    v_max3_f32 v246, v246, v149, v150
    v_max3_f32 v247, v247, v165, v166
    v_max3_f32 v246, v246, v151, v152
    v_max3_f32 v247, v247, v167, v168
    v_max3_f32 v246, v246, v153, v154
    v_max3_f32 v247, v247, v169, v170
    v_max3_f32 v246, v246, v155, v156
    v_max3_f32 v247, v247, v171, v172
    v_max3_f32 v246, v246, v157, v158
    v_max3_f32 v247, v247, v173, v174
    v_max3_f32 v246, v246, v159, v175
    v_max_f32 v246, v246, v247
    v_max3_f32 v248, v216, v217, v218
    v_max_f32 v248, v248, v219
    v_mov_b32 v247, v246
    v_mov_b32 v249, v248
    s_nop 1
    v_permlane32_swap_b32 v246, v247
    v_permlane32_swap_b32 v248, v249
    s_nop 1
    v_max_f32 v246, v246, v247
    v_max_f32 v248, v248, v249
    v_mov_b32 v249, v248
    v_mul_f32 v246, s11, v246
    s_nop 1
    v_permlane16_swap_b32 v248, v249
    s_nop 1
    v_max_f32 v248, v248, v249
    v_mul_f32 v248, s11, v248
    v_add_f32 v250, s12, v242
    v_cmp_gt_f32 vcc, v246, v250
    s_nop 1
    s_cbranch_vccz L_nors_11
    v_max_f32 v250, v242, v246
    v_sub_f32 v251, v242, v250
    v_exp_f32 v251, v251
    v_mov_b32 v242, v250
    v_mul_f32 v243, v243, v251
    v_mul_f32 v0, v0, v251
    v_mul_f32 v1, v1, v251
    v_mul_f32 v2, v2, v251
    v_mul_f32 v3, v3, v251
    v_mul_f32 v4, v4, v251
    v_mul_f32 v5, v5, v251
    v_mul_f32 v6, v6, v251
    v_mul_f32 v7, v7, v251
    v_mul_f32 v8, v8, v251
    v_mul_f32 v9, v9, v251
    v_mul_f32 v10, v10, v251
    v_mul_f32 v11, v11, v251
    v_mul_f32 v12, v12, v251
    v_mul_f32 v13, v13, v251
    v_mul_f32 v14, v14, v251
    v_mul_f32 v15, v15, v251
    v_mul_f32 v16, v16, v251
    v_mul_f32 v17, v17, v251
    v_mul_f32 v18, v18, v251
    v_mul_f32 v19, v19, v251
    v_mul_f32 v20, v20, v251
    v_mul_f32 v21, v21, v251
    v_mul_f32 v22, v22, v251
    v_mul_f32 v23, v23, v251
    v_mul_f32 v24, v24, v251
    v_mul_f32 v25, v25, v251
    v_mul_f32 v26, v26, v251
    v_mul_f32 v27, v27, v251
    v_mul_f32 v28, v28, v251
    v_mul_f32 v29, v29, v251
    v_mul_f32 v30, v30, v251
    v_mul_f32 v31, v31, v251
    v_mul_f32 v32, v32, v251
    v_mul_f32 v33, v33, v251
    v_mul_f32 v34, v34, v251
    v_mul_f32 v35, v35, v251
    v_mul_f32 v36, v36, v251
    v_mul_f32 v37, v37, v251
    v_mul_f32 v38, v38, v251
    v_mul_f32 v39, v39, v251
    v_mul_f32 v40, v40, v251
    v_mul_f32 v41, v41, v251
    v_mul_f32 v42, v42, v251
    v_mul_f32 v43, v43, v251
    v_mul_f32 v44, v44, v251
    v_mul_f32 v45, v45, v251
    v_mul_f32 v46, v46, v251
    v_mul_f32 v47, v47, v251
    v_mul_f32 v48, v48, v251
    v_mul_f32 v49, v49, v251
    v_mul_f32 v50, v50, v251
    v_mul_f32 v51, v51, v251
    v_mul_f32 v52, v52, v251
    v_mul_f32 v53, v53, v251
    v_mul_f32 v54, v54, v251
    v_mul_f32 v55, v55, v251
    v_mul_f32 v56, v56, v251
    v_mul_f32 v57, v57, v251
    v_mul_f32 v58, v58, v251
    v_mul_f32 v59, v59, v251
    v_mul_f32 v60, v60, v251
    v_mul_f32 v61, v61, v251
    v_mul_f32 v62, v62, v251
    v_mul_f32 v63, v63, v251
L_nors_11:
    v_add_f32 v250, s12, v244
    v_cmp_gt_f32 vcc, v248, v250
    s_nop 1
    s_cbranch_vccz L_nors_12
    v_max_f32 v250, v244, v248
    v_sub_f32 v251, v244, v250
    v_exp_f32 v251, v251
    v_mov_b32 v244, v250
    v_mul_f32 v245, v245, v251
    v_mul_f32 v64, v64, v251
    v_mul_f32 v65, v65, v251
    v_mul_f32 v66, v66, v251
    v_mul_f32 v67, v67, v251
    v_mul_f32 v68, v68, v251
    v_mul_f32 v69, v69, v251
    v_mul_f32 v70, v70, v251
    v_mul_f32 v71, v71, v251
    v_mul_f32 v72, v72, v251
    v_mul_f32 v73, v73, v251
    v_mul_f32 v74, v74, v251
    v_mul_f32 v75, v75, v251
    v_mul_f32 v76, v76, v251
    v_mul_f32 v77, v77, v251
    v_mul_f32 v78, v78, v251
    v_mul_f32 v79, v79, v251
    v_mul_f32 v80, v80, v251
    v_mul_f32 v81, v81, v251
    v_mul_f32 v82, v82, v251
    v_mul_f32 v83, v83, v251
    v_mul_f32 v84, v84, v251
    v_mul_f32 v85, v85, v251
    v_mul_f32 v86, v86, v251
    v_mul_f32 v87, v87, v251
    v_mul_f32 v88, v88, v251
    v_mul_f32 v89, v89, v251
    v_mul_f32 v90, v90, v251
    v_mul_f32 v91, v91, v251
    v_mul_f32 v92, v92, v251
    v_mul_f32 v93, v93, v251
    v_mul_f32 v94, v94, v251
    v_mul_f32 v95, v95, v251
L_nors_12:
    v_fma_f32 v144, v144, s11, -v242
    v_fma_f32 v145, v145, s11, -v242
    v_fma_f32 v146, v146, s11, -v242
    v_fma_f32 v147, v147, s11, -v242
    v_fma_f32 v148, v148, s11, -v242
    v_fma_f32 v149, v149, s11, -v242
    v_fma_f32 v150, v150, s11, -v242
    v_fma_f32 v151, v151, s11, -v242
    v_fma_f32 v152, v152, s11, -v242
    v_fma_f32 v153, v153, s11, -v242
    v_fma_f32 v154, v154, s11, -v242
    v_fma_f32 v155, v155, s11, -v242
    v_fma_f32 v156, v156, s11, -v242
    v_fma_f32 v157, v157, s11, -v242
    v_fma_f32 v158, v158, s11, -v242
    v_fma_f32 v159, v159, s11, -v242
    v_fma_f32 v160, v160, s11, -v242
    v_fma_f32 v161, v161, s11, -v242
    v_fma_f32 v162, v162, s11, -v242
    v_fma_f32 v163, v163, s11, -v242
    v_fma_f32 v164, v164, s11, -v242
    v_fma_f32 v165, v165, s11, -v242
    v_fma_f32 v166, v166, s11, -v242
    v_fma_f32 v167, v167, s11, -v242
    v_fma_f32 v168, v168, s11, -v242
    v_fma_f32 v169, v169, s11, -v242
    v_fma_f32 v170, v170, s11, -v242
    v_fma_f32 v171, v171, s11, -v242
    v_fma_f32 v172, v172, s11, -v242
    v_fma_f32 v173, v173, s11, -v242
    v_fma_f32 v174, v174, s11, -v242
    v_fma_f32 v175, v175, s11, -v242
    v_fma_f32 v216, v216, s11, -v244
    v_fma_f32 v217, v217, s11, -v244
    v_fma_f32 v218, v218, s11, -v244
    v_fma_f32 v219, v219, s11, -v244
    v_exp_f32 v144, v144
    v_exp_f32 v145, v145
    v_exp_f32 v146, v146
    v_exp_f32 v147, v147
    v_exp_f32 v148, v148
    v_exp_f32 v149, v149
    v_exp_f32 v150, v150
    v_exp_f32 v151, v151
    v_exp_f32 v152, v152
    v_exp_f32 v153, v153
    v_exp_f32 v154, v154
    v_exp_f32 v155, v155
    v_exp_f32 v156, v156
    v_exp_f32 v157, v157
    v_exp_f32 v158, v158
    v_exp_f32 v159, v159
    v_exp_f32 v160, v160
    v_exp_f32 v161, v161
    v_exp_f32 v162, v162
    v_exp_f32 v163, v163
    v_exp_f32 v164, v164
    v_exp_f32 v165, v165
    v_exp_f32 v166, v166
    v_exp_f32 v167, v167
    v_exp_f32 v168, v168
    v_exp_f32 v169, v169
    v_exp_f32 v170, v170
    v_exp_f32 v171, v171
    v_exp_f32 v172, v172
    v_exp_f32 v173, v173
    v_exp_f32 v174, v174
    v_exp_f32 v175, v175
    v_exp_f32 v216, v216
    v_exp_f32 v217, v217
    v_exp_f32 v218, v218
    v_exp_f32 v219, v219
    v_add_f32 v246, v144, v145
    v_add_f32 v247, v146, v147
    v_add_f32 v246, v246, v148
    v_add_f32 v247, v247, v149
    v_add_f32 v246, v246, v150
    v_add_f32 v247, v247, v151
    v_add_f32 v246, v246, v152
    v_add_f32 v247, v247, v153
    v_add_f32 v246, v246, v154
    v_add_f32 v247, v247, v155
    v_add_f32 v246, v246, v156
    v_add_f32 v247, v247, v157
    v_add_f32 v246, v246, v158
    v_add_f32 v247, v247, v159
    v_add_f32 v246, v246, v160
    v_add_f32 v247, v247, v161
    v_add_f32 v246, v246, v162
    v_add_f32 v247, v247, v163
    v_add_f32 v246, v246, v164
    v_add_f32 v247, v247, v165
    v_add_f32 v246, v246, v166
    v_add_f32 v247, v247, v167
    v_add_f32 v246, v246, v168
    v_add_f32 v247, v247, v169
    v_add_f32 v246, v246, v170
    v_add_f32 v247, v247, v171
    v_add_f32 v246, v246, v172
    v_add_f32 v247, v247, v173
    v_add_f32 v246, v246, v174
    v_add_f32 v247, v247, v175
    v_cvt_pk_bf16_f32 v176, v144, v145
    v_cvt_pk_bf16_f32 v177, v146, v147
    v_cvt_pk_bf16_f32 v178, v148, v149
    v_cvt_pk_bf16_f32 v179, v150, v151
    v_cvt_pk_bf16_f32 v180, v152, v153
    v_cvt_pk_bf16_f32 v181, v154, v155
    v_cvt_pk_bf16_f32 v182, v156, v157
    v_cvt_pk_bf16_f32 v183, v158, v159
    v_cvt_pk_bf16_f32 v184, v160, v161
    v_cvt_pk_bf16_f32 v185, v162, v163
    v_cvt_pk_bf16_f32 v186, v164, v165
    v_cvt_pk_bf16_f32 v187, v166, v167
    v_cvt_pk_bf16_f32 v188, v168, v169
    v_cvt_pk_bf16_f32 v189, v170, v171
    v_cvt_pk_bf16_f32 v190, v172, v173
    v_cvt_pk_bf16_f32 v191, v174, v175
    v_add_f32 v248, v216, v217
    v_add_f32 v249, v218, v219
    v_cvt_pk_bf16_f32 v220, v216, v217
    v_cvt_pk_bf16_f32 v221, v218, v219
    v_add_f32 v246, v246, v247
    v_add_f32 v248, v248, v249
    v_add_f32 v243, v243, v246
    v_add_f32 v245, v245, v248
    s_waitcnt vmcnt(8)
    s_barrier
    s_cmp_eq_u32 s87, 0
    s_cbranch_scc1 L_w_13
    s_add_u32 s10, s7, s72
    s_and_b32 s10, s10, 0x1ffff
    s_and_b32 s13, s7, 0x20000
    s_add_u32 s10, s10, s13
    s_add_u32 s10, s10, s42
    s_cmp_lt_u32 s7, 0x40000
    s_cselect_b32 s10, s10, 0x7f000000
    s_add_u32 m0, s9, 0x0
    s_add_u32 s7, s7, 16384
    buffer_load_dwordx4 v237, s[48:51], s10 offen nt lds
    s_add_u32 m0, s9, 0x1000
    s_add_u32 s10, s10, 4096
    buffer_load_dwordx4 v237, s[48:51], s10 offen nt lds
    s_add_u32 m0, s9, 0x2000
    s_add_u32 s10, s10, 4096
    buffer_load_dwordx4 v237, s[48:51], s10 offen nt lds
    s_add_u32 m0, s9, 0x3000
    s_add_u32 s10, s10, 4096
    buffer_load_dwordx4 v237, s[48:51], s10 offen nt lds
    s_branch L_e_14
L_w_13:
    s_add_u32 m0, s9, 0x0
    s_add_u32 s10, s74, 0x0
    buffer_load_dwordx4 v239, s[56:59], s10 offen lds
    s_add_u32 m0, s9, 0x1000
    s_add_u32 s10, s74, 0x20000
    buffer_load_dwordx4 v239, s[56:59], s10 offen lds
    s_add_u32 m0, s76, 0x0
    s_add_u32 s74, s74, 0x40000
    buffer_load_dwordx4 v240, s[44:47], s75 offen lds
    s_add_u32 m0, s76, 0x400
    s_nop 0
    buffer_load_dwordx4 v212, s[44:47], s75 offen lds
    s_add_u32 m0, s77, 0x0
    s_mov_b64 exec, 0xffff
    buffer_load_dwordx4 v241, s[44:47], s75 offen lds
    s_mov_b64 exec, -1
    s_add_u32 s75, s75, 64
L_e_14:
    v_xor_b32 v247, 64, v235
    v_xor_b32 v248, 128, v235
    v_xor_b32 v249, 192, v235
    ds_read_b64_tr_b16 v[192:193], v230 offset:16384
    ds_read_b64_tr_b16 v[194:195], v230 offset:17408
    ds_read_b64_tr_b16 v[196:197], v231 offset:16384
    ds_read_b64_tr_b16 v[198:199], v231 offset:17408
    ds_read_b64_tr_b16 v[200:201], v232 offset:16384
    ds_read_b64_tr_b16 v[202:203], v232 offset:17408
    ds_read_b64_tr_b16 v[204:205], v233 offset:16384
    ds_read_b64_tr_b16 v[206:207], v233 offset:17408
    s_waitcnt lgkmcnt(6)
    v_mfma_f32_32x32x16_bf16 v[0:15], v[192:195], v[176:179], v[0:15]
    ds_read_b64_tr_b16 v[208:209], v235 offset:16384
    ds_read_b64_tr_b16 v[210:211], v235 offset:16392
    s_waitcnt lgkmcnt(6)
    v_mfma_f32_32x32x16_bf16 v[16:31], v[196:199], v[176:179], v[16:31]
    ds_read_b64_tr_b16 v[192:193], v230 offset:20480
    ds_read_b64_tr_b16 v[194:195], v230 offset:21504
    s_waitcnt lgkmcnt(6)
    v_mfma_f32_32x32x16_bf16 v[32:47], v[200:203], v[176:179], v[32:47]
    ds_read_b64_tr_b16 v[196:197], v231 offset:20480
    ds_read_b64_tr_b16 v[198:199], v231 offset:21504
    s_waitcnt lgkmcnt(6)
    v_mfma_f32_32x32x16_bf16 v[48:63], v[204:207], v[176:179], v[48:63]
    ds_read_b64_tr_b16 v[200:201], v232 offset:20480
    ds_read_b64_tr_b16 v[202:203], v232 offset:21504
    s_waitcnt lgkmcnt(6)
    v_mfma_f32_16x16x16_bf16 v[64:67], v[208:209], v[220:221], v[64:67]
    v_mfma_f32_16x16x16_bf16 v[68:71], v[210:211], v[220:221], v[68:71]
    ds_read_b64_tr_b16 v[204:205], v233 offset:20480
    ds_read_b64_tr_b16 v[206:207], v233 offset:21504
    s_waitcnt lgkmcnt(6)
    v_mfma_f32_32x32x16_bf16 v[0:15], v[192:195], v[180:183], v[0:15]
    ds_read_b64_tr_b16 v[208:209], v247 offset:16384
    ds_read_b64_tr_b16 v[210:211], v247 offset:16392
    s_waitcnt lgkmcnt(6)
    v_mfma_f32_32x32x16_bf16 v[16:31], v[196:199], v[180:183], v[16:31]
    ds_read_b64_tr_b16 v[192:193], v230 offset:24576
    ds_read_b64_tr_b16 v[194:195], v230 offset:25600
    s_waitcnt lgkmcnt(6)
    v_mfma_f32_32x32x16_bf16 v[32:47], v[200:203], v[180:183], v[32:47]
    ds_read_b64_tr_b16 v[196:197], v231 offset:24576
    ds_read_b64_tr_b16 v[198:199], v231 offset:25600
    s_waitcnt lgkmcnt(6)
    v_mfma_f32_32x32x16_bf16 v[48:63], v[204:207], v[180:183], v[48:63]
    ds_read_b64_tr_b16 v[200:201], v232 offset:24576
    ds_read_b64_tr_b16 v[202:203], v232 offset:25600
    s_waitcnt lgkmcnt(6)
    v_mfma_f32_16x16x16_bf16 v[72:75], v[208:209], v[220:221], v[72:75]
    v_mfma_f32_16x16x16_bf16 v[76:79], v[210:211], v[220:221], v[76:79]
    ds_read_b64_tr_b16 v[204:205], v233 offset:24576
    ds_read_b64_tr_b16 v[206:207], v233 offset:25600
    s_waitcnt lgkmcnt(6)
    v_mfma_f32_32x32x16_bf16 v[0:15], v[192:195], v[184:187], v[0:15]
    ds_read_b64_tr_b16 v[208:209], v248 offset:16384
    ds_read_b64_tr_b16 v[210:211], v248 offset:16392
    s_waitcnt lgkmcnt(6)
    v_mfma_f32_32x32x16_bf16 v[16:31], v[196:199], v[184:187], v[16:31]
    ds_read_b64_tr_b16 v[192:193], v230 offset:28672
    ds_read_b64_tr_b16 v[194:195], v230 offset:29696
    s_waitcnt lgkmcnt(6)
    v_mfma_f32_32x32x16_bf16 v[32:47], v[200:203], v[184:187], v[32:47]
    ds_read_b64_tr_b16 v[196:197], v231 offset:28672
    ds_read_b64_tr_b16 v[198:199], v231 offset:29696
    s_waitcnt lgkmcnt(6)
    v_mfma_f32_32x32x16_bf16 v[48:63], v[204:207], v[184:187], v[48:63]
    ds_read_b64_tr_b16 v[200:201], v232 offset:28672
    ds_read_b64_tr_b16 v[202:203], v232 offset:29696
    s_waitcnt lgkmcnt(6)
    v_mfma_f32_16x16x16_bf16 v[80:83], v[208:209], v[220:221], v[80:83]
    v_mfma_f32_16x16x16_bf16 v[84:87], v[210:211], v[220:221], v[84:87]
    ds_read_b64_tr_b16 v[204:205], v233 offset:28672
    ds_read_b64_tr_b16 v[206:207], v233 offset:29696
    s_waitcnt lgkmcnt(6)
    v_mfma_f32_32x32x16_bf16 v[0:15], v[192:195], v[188:191], v[0:15]
    ds_read_b64_tr_b16 v[208:209], v249 offset:16384
    ds_read_b64_tr_b16 v[210:211], v249 offset:16392
    s_waitcnt lgkmcnt(6)
    v_mfma_f32_32x32x16_bf16 v[16:31], v[196:199], v[188:191], v[16:31]
    s_waitcnt lgkmcnt(4)
    v_mfma_f32_32x32x16_bf16 v[32:47], v[200:203], v[188:191], v[32:47]
    s_waitcnt lgkmcnt(2)
    v_mfma_f32_32x32x16_bf16 v[48:63], v[204:207], v[188:191], v[48:63]
    s_waitcnt lgkmcnt(0)
    v_mfma_f32_16x16x16_bf16 v[88:91], v[208:209], v[220:221], v[88:91]
    v_mfma_f32_16x16x16_bf16 v[92:95], v[210:211], v[220:221], v[92:95]
    s_waitcnt vmcnt(8)
    s_barrier
    s_cmp_eq_u32 s87, 0
    s_cbranch_scc1 L_w_15
    s_add_u32 s10, s8, s72
    s_and_b32 s10, s10, 0x1ffff
    s_and_b32 s13, s8, 0x20000
    s_add_u32 s10, s10, s13
    s_add_u32 s10, s10, s42
    s_cmp_lt_u32 s8, 0x40000
    s_cselect_b32 s10, s10, 0x7f000000
    s_add_u32 m0, s9, 0x4000
    s_add_u32 s8, s8, 16384
    buffer_load_dwordx4 v238, s[52:55], s10 offen nt lds
    s_add_u32 m0, s9, 0x5000
    s_add_u32 s10, s10, 4096
    buffer_load_dwordx4 v238, s[52:55], s10 offen nt lds
    s_add_u32 m0, s9, 0x6000
    s_add_u32 s10, s10, 4096
    buffer_load_dwordx4 v238, s[52:55], s10 offen nt lds
    s_add_u32 m0, s9, 0x7000
    s_add_u32 s10, s10, 4096
    buffer_load_dwordx4 v238, s[52:55], s10 offen nt lds
    s_branch L_e_16
L_w_15:
    s_add_u32 m0, s9, 0x4000
    s_add_u32 s10, s74, 0x0
    buffer_load_dwordx4 v239, s[56:59], s10 offen lds
    s_add_u32 m0, s9, 0x5000
    s_add_u32 s10, s74, 0x20000
    buffer_load_dwordx4 v239, s[56:59], s10 offen lds
    s_add_u32 m0, s76, 0x4000
    s_add_u32 s74, s74, 0x40000
    buffer_load_dwordx4 v240, s[44:47], s75 offen lds
    s_add_u32 m0, s76, 0x4400
    s_nop 0
    buffer_load_dwordx4 v212, s[44:47], s75 offen lds
    s_add_u32 m0, s77, 0x400
    s_mov_b64 exec, 0xffff
    buffer_load_dwordx4 v241, s[44:47], s75 offen lds
    s_mov_b64 exec, -1
    s_add_u32 s75, s75, 64
L_e_16:
    v_xor_b32 v247, 64, v234
    v_xor_b32 v248, 128, v234
    v_xor_b32 v249, 192, v234
    ds_read_b128 v[192:195], v222 offset:32768
    ds_read_b128 v[196:199], v223 offset:32768
    ds_read_b128 v[200:203], v224 offset:32768
    ds_read_b128 v[204:207], v225 offset:32768
    s_waitcnt lgkmcnt(3)
    v_mfma_f32_32x32x16_bf16 v[144:159], v[192:195], v[96:99], 0
    ds_read_b128 v[208:211], v226 offset:32768
    s_waitcnt lgkmcnt(3)
    v_mfma_f32_32x32x16_bf16 v[144:159], v[196:199], v[100:103], v[144:159]
    ds_read_b128 v[192:195], v227 offset:32768
    s_waitcnt lgkmcnt(3)
    v_mfma_f32_32x32x16_bf16 v[144:159], v[200:203], v[104:107], v[144:159]
    ds_read_b128 v[196:199], v228 offset:32768
    s_waitcnt lgkmcnt(3)
    v_mfma_f32_32x32x16_bf16 v[144:159], v[204:207], v[108:111], v[144:159]
    ds_read_b128 v[200:203], v229 offset:32768
    s_waitcnt lgkmcnt(3)
    v_mfma_f32_32x32x16_bf16 v[144:159], v[208:211], v[112:115], v[144:159]
    ds_read_b128 v[204:207], v222 offset:40960
    s_waitcnt lgkmcnt(3)
    v_mfma_f32_32x32x16_bf16 v[144:159], v[192:195], v[116:119], v[144:159]
    ds_read_b128 v[208:211], v223 offset:40960
    s_waitcnt lgkmcnt(3)
    v_mfma_f32_32x32x16_bf16 v[144:159], v[196:199], v[120:123], v[144:159]
    ds_read_b128 v[192:195], v224 offset:40960
    s_waitcnt lgkmcnt(3)
    v_mfma_f32_32x32x16_bf16 v[144:159], v[200:203], v[124:127], v[144:159]
    ds_read_b128 v[196:199], v225 offset:40960
    s_waitcnt lgkmcnt(3)
    v_mfma_f32_32x32x16_bf16 v[160:175], v[204:207], v[96:99], 0
    ds_read_b128 v[200:203], v226 offset:40960
    s_waitcnt lgkmcnt(3)
    v_mfma_f32_32x32x16_bf16 v[160:175], v[208:211], v[100:103], v[160:175]
    ds_read_b128 v[204:207], v227 offset:40960
    s_waitcnt lgkmcnt(3)
    v_mfma_f32_32x32x16_bf16 v[160:175], v[192:195], v[104:107], v[160:175]
    ds_read_b128 v[208:211], v228 offset:40960
    s_waitcnt lgkmcnt(3)
    v_mfma_f32_32x32x16_bf16 v[160:175], v[196:199], v[108:111], v[160:175]
    ds_read_b128 v[192:195], v229 offset:40960
    s_waitcnt lgkmcnt(3)
    v_mfma_f32_32x32x16_bf16 v[160:175], v[200:203], v[112:115], v[160:175]
    ds_read_b128 v[196:199], v234 offset:32768
    s_waitcnt lgkmcnt(3)
    v_mfma_f32_32x32x16_bf16 v[160:175], v[204:207], v[116:119], v[160:175]
    ds_read_b128 v[200:203], v247 offset:32768
    s_waitcnt lgkmcnt(3)
    v_mfma_f32_32x32x16_bf16 v[160:175], v[208:211], v[120:123], v[160:175]
    ds_read_b128 v[204:207], v248 offset:32768
    s_waitcnt lgkmcnt(3)
    v_mfma_f32_32x32x16_bf16 v[160:175], v[192:195], v[124:127], v[160:175]
    ds_read_b128 v[208:211], v249 offset:32768
    s_waitcnt lgkmcnt(3)
    v_mfma_f32_16x16x32_bf16 v[216:219], v[196:199], v[128:131], 0
    s_waitcnt lgkmcnt(2)
    v_mfma_f32_16x16x32_bf16 v[216:219], v[200:203], v[132:135], v[216:219]
    s_waitcnt lgkmcnt(1)
    v_mfma_f32_16x16x32_bf16 v[216:219], v[204:207], v[136:139], v[216:219]
    s_waitcnt lgkmcnt(0)
    v_mfma_f32_16x16x32_bf16 v[216:219], v[208:211], v[140:143], v[216:219]
    s_nop 3
    v_max3_f32 v246, v144, v145, v146
    v_max3_f32 v247, v160, v161, v162
    v_max3_f32 v246, v246, v147, v148
    v_max3_f32 v247, v247, v163, v164
    v_max3_f32 v246, v246, v149, v150
    v_max3_f32 v247, v247, v165, v166
    v_max3_f32 v246, v246, v151, v152
    v_max3_f32 v247, v247, v167, v168
    v_max3_f32 v246, v246, v153, v154
    v_max3_f32 v247, v247, v169, v170
    v_max3_f32 v246, v246, v155, v156
    v_max3_f32 v247, v247, v171, v172
    v_max3_f32 v246, v246, v157, v158
    v_max3_f32 v247, v247, v173, v174
    v_max3_f32 v246, v246, v159, v175
    v_max_f32 v246, v246, v247
    v_max3_f32 v248, v216, v217, v218
    v_max_f32 v248, v248, v219
    v_mov_b32 v247, v246
    v_mov_b32 v249, v248
    s_nop 1
    v_permlane32_swap_b32 v246, v247
    v_permlane32_swap_b32 v248, v249
    s_nop 1
    v_max_f32 v246, v246, v247
    v_max_f32 v248, v248, v249
    v_mov_b32 v249, v248
    v_mul_f32 v246, s11, v246
    s_nop 1
    v_permlane16_swap_b32 v248, v249
    s_nop 1
    v_max_f32 v248, v248, v249
    v_mul_f32 v248, s11, v248
    v_add_f32 v250, s12, v242
    v_cmp_gt_f32 vcc, v246, v250
    s_nop 1
    s_cbranch_vccz L_nors_17
    v_max_f32 v250, v242, v246
    v_sub_f32 v251, v242, v250
    v_exp_f32 v251, v251
    v_mov_b32 v242, v250
    v_mul_f32 v243, v243, v251
    v_mul_f32 v0, v0, v251
    v_mul_f32 v1, v1, v251
    v_mul_f32 v2, v2, v251
    v_mul_f32 v3, v3, v251
    v_mul_f32 v4, v4, v251
    v_mul_f32 v5, v5, v251
    v_mul_f32 v6, v6, v251
    v_mul_f32 v7, v7, v251
    v_mul_f32 v8, v8, v251
    v_mul_f32 v9, v9, v251
    v_mul_f32 v10, v10, v251
    v_mul_f32 v11, v11, v251
    v_mul_f32 v12, v12, v251
    v_mul_f32 v13, v13, v251
    v_mul_f32 v14, v14, v251
    v_mul_f32 v15, v15, v251
    v_mul_f32 v16, v16, v251
    v_mul_f32 v17, v17, v251
    v_mul_f32 v18, v18, v251
    v_mul_f32 v19, v19, v251
    v_mul_f32 v20, v20, v251
    v_mul_f32 v21, v21, v251
    v_mul_f32 v22, v22, v251
    v_mul_f32 v23, v23, v251
    v_mul_f32 v24, v24, v251
    v_mul_f32 v25, v25, v251
    v_mul_f32 v26, v26, v251
    v_mul_f32 v27, v27, v251
    v_mul_f32 v28, v28, v251
    v_mul_f32 v29, v29, v251
    v_mul_f32 v30, v30, v251
    v_mul_f32 v31, v31, v251
    v_mul_f32 v32, v32, v251
    v_mul_f32 v33, v33, v251
    v_mul_f32 v34, v34, v251
    v_mul_f32 v35, v35, v251
    v_mul_f32 v36, v36, v251
    v_mul_f32 v37, v37, v251
    v_mul_f32 v38, v38, v251
    v_mul_f32 v39, v39, v251
    v_mul_f32 v40, v40, v251
    v_mul_f32 v41, v41, v251
    v_mul_f32 v42, v42, v251
    v_mul_f32 v43, v43, v251
    v_mul_f32 v44, v44, v251
    v_mul_f32 v45, v45, v251
    v_mul_f32 v46, v46, v251
    v_mul_f32 v47, v47, v251
    v_mul_f32 v48, v48, v251
    v_mul_f32 v49, v49, v251
    v_mul_f32 v50, v50, v251
    v_mul_f32 v51, v51, v251
    v_mul_f32 v52, v52, v251
    v_mul_f32 v53, v53, v251
    v_mul_f32 v54, v54, v251
    v_mul_f32 v55, v55, v251
    v_mul_f32 v56, v56, v251
    v_mul_f32 v57, v57, v251
    v_mul_f32 v58, v58, v251
    v_mul_f32 v59, v59, v251
    v_mul_f32 v60, v60, v251
    v_mul_f32 v61, v61, v251
    v_mul_f32 v62, v62, v251
    v_mul_f32 v63, v63, v251
L_nors_17:
    v_add_f32 v250, s12, v244
    v_cmp_gt_f32 vcc, v248, v250
    s_nop 1
    s_cbranch_vccz L_nors_18
    v_max_f32 v250, v244, v248
    v_sub_f32 v251, v244, v250
    v_exp_f32 v251, v251
    v_mov_b32 v244, v250
    v_mul_f32 v245, v245, v251
    v_mul_f32 v64, v64, v251
    v_mul_f32 v65, v65, v251
    v_mul_f32 v66, v66, v251
    v_mul_f32 v67, v67, v251
    v_mul_f32 v68, v68, v251
    v_mul_f32 v69, v69, v251
    v_mul_f32 v70, v70, v251
    v_mul_f32 v71, v71, v251
    v_mul_f32 v72, v72, v251
    v_mul_f32 v73, v73, v251
    v_mul_f32 v74, v74, v251
    v_mul_f32 v75, v75, v251
    v_mul_f32 v76, v76, v251
    v_mul_f32 v77, v77, v251
    v_mul_f32 v78, v78, v251
    v_mul_f32 v79, v79, v251
    v_mul_f32 v80, v80, v251
    v_mul_f32 v81, v81, v251
    v_mul_f32 v82, v82, v251
    v_mul_f32 v83, v83, v251
    v_mul_f32 v84, v84, v251
    v_mul_f32 v85, v85, v251
    v_mul_f32 v86, v86, v251
    v_mul_f32 v87, v87, v251
    v_mul_f32 v88, v88, v251
    v_mul_f32 v89, v89, v251
    v_mul_f32 v90, v90, v251
    v_mul_f32 v91, v91, v251
    v_mul_f32 v92, v92, v251
    v_mul_f32 v93, v93, v251
    v_mul_f32 v94, v94, v251
    v_mul_f32 v95, v95, v251
L_nors_18:
    v_fma_f32 v144, v144, s11, -v242
    v_fma_f32 v145, v145, s11, -v242
    v_fma_f32 v146, v146, s11, -v242
    v_fma_f32 v147, v147, s11, -v242
    v_fma_f32 v148, v148, s11, -v242
    v_fma_f32 v149, v149, s11, -v242
    v_fma_f32 v150, v150, s11, -v242
    v_fma_f32 v151, v151, s11, -v242
    v_fma_f32 v152, v152, s11, -v242
    v_fma_f32 v153, v153, s11, -v242
    v_fma_f32 v154, v154, s11, -v242
    v_fma_f32 v155, v155, s11, -v242
    v_fma_f32 v156, v156, s11, -v242
    v_fma_f32 v157, v157, s11, -v242
    v_fma_f32 v158, v158, s11, -v242
    v_fma_f32 v159, v159, s11, -v242
    v_fma_f32 v160, v160, s11, -v242
    v_fma_f32 v161, v161, s11, -v242
    v_fma_f32 v162, v162, s11, -v242
    v_fma_f32 v163, v163, s11, -v242
    v_fma_f32 v164, v164, s11, -v242
    v_fma_f32 v165, v165, s11, -v242
    v_fma_f32 v166, v166, s11, -v242
    v_fma_f32 v167, v167, s11, -v242
    v_fma_f32 v168, v168, s11, -v242
    v_fma_f32 v169, v169, s11, -v242
    v_fma_f32 v170, v170, s11, -v242
    v_fma_f32 v171, v171, s11, -v242
    v_fma_f32 v172, v172, s11, -v242
    v_fma_f32 v173, v173, s11, -v242
    v_fma_f32 v174, v174, s11, -v242
    v_fma_f32 v175, v175, s11, -v242
    v_fma_f32 v216, v216, s11, -v244
    v_fma_f32 v217, v217, s11, -v244
    v_fma_f32 v218, v218, s11, -v244
    v_fma_f32 v219, v219, s11, -v244
    v_exp_f32 v144, v144
    v_exp_f32 v145, v145
    v_exp_f32 v146, v146
    v_exp_f32 v147, v147
    v_exp_f32 v148, v148
    v_exp_f32 v149, v149
    v_exp_f32 v150, v150
    v_exp_f32 v151, v151
    v_exp_f32 v152, v152
    v_exp_f32 v153, v153
    v_exp_f32 v154, v154
    v_exp_f32 v155, v155
    v_exp_f32 v156, v156
    v_exp_f32 v157, v157
    v_exp_f32 v158, v158
    v_exp_f32 v159, v159
    v_exp_f32 v160, v160
    v_exp_f32 v161, v161
    v_exp_f32 v162, v162
    v_exp_f32 v163, v163
    v_exp_f32 v164, v164
    v_exp_f32 v165, v165
    v_exp_f32 v166, v166
    v_exp_f32 v167, v167
    v_exp_f32 v168, v168
    v_exp_f32 v169, v169
    v_exp_f32 v170, v170
    v_exp_f32 v171, v171
    v_exp_f32 v172, v172
    v_exp_f32 v173, v173
    v_exp_f32 v174, v174
    v_exp_f32 v175, v175
    v_exp_f32 v216, v216
    v_exp_f32 v217, v217
    v_exp_f32 v218, v218
    v_exp_f32 v219, v219
    v_add_f32 v246, v144, v145
    v_add_f32 v247, v146, v147
    v_add_f32 v246, v246, v148
    v_add_f32 v247, v247, v149
    v_add_f32 v246, v246, v150
    v_add_f32 v247, v247, v151
    v_add_f32 v246, v246, v152
    v_add_f32 v247, v247, v153
    v_add_f32 v246, v246, v154
    v_add_f32 v247, v247, v155
    v_add_f32 v246, v246, v156
    v_add_f32 v247, v247, v157
    v_add_f32 v246, v246, v158
    v_add_f32 v247, v247, v159
    v_add_f32 v246, v246, v160
    v_add_f32 v247, v247, v161
    v_add_f32 v246, v246, v162
    v_add_f32 v247, v247, v163
    v_add_f32 v246, v246, v164
    v_add_f32 v247, v247, v165
    v_add_f32 v246, v246, v166
    v_add_f32 v247, v247, v167
    v_add_f32 v246, v246, v168
    v_add_f32 v247, v247, v169
    v_add_f32 v246, v246, v170
    v_add_f32 v247, v247, v171
    v_add_f32 v246, v246, v172
    v_add_f32 v247, v247, v173
    v_add_f32 v246, v246, v174
    v_add_f32 v247, v247, v175
    v_cvt_pk_bf16_f32 v176, v144, v145
    v_cvt_pk_bf16_f32 v177, v146, v147
    v_cvt_pk_bf16_f32 v178, v148, v149
    v_cvt_pk_bf16_f32 v179, v150, v151
    v_cvt_pk_bf16_f32 v180, v152, v153
    v_cvt_pk_bf16_f32 v181, v154, v155
    v_cvt_pk_bf16_f32 v182, v156, v157
    v_cvt_pk_bf16_f32 v183, v158, v159
    v_cvt_pk_bf16_f32 v184, v160, v161
    v_cvt_pk_bf16_f32 v185, v162, v163
    v_cvt_pk_bf16_f32 v186, v164, v165
    v_cvt_pk_bf16_f32 v187, v166, v167
    v_cvt_pk_bf16_f32 v188, v168, v169
    v_cvt_pk_bf16_f32 v189, v170, v171
    v_cvt_pk_bf16_f32 v190, v172, v173
    v_cvt_pk_bf16_f32 v191, v174, v175
    v_add_f32 v248, v216, v217
    v_add_f32 v249, v218, v219
    v_cvt_pk_bf16_f32 v220, v216, v217
    v_cvt_pk_bf16_f32 v221, v218, v219
    v_add_f32 v246, v246, v247
    v_add_f32 v248, v248, v249
    v_add_f32 v243, v243, v246
    v_add_f32 v245, v245, v248
    s_waitcnt vmcnt(8)
    s_barrier
    s_cmp_eq_u32 s87, 0
    s_cbranch_scc1 L_w_19
    s_add_u32 s10, s7, s72
    s_and_b32 s10, s10, 0x1ffff
    s_and_b32 s13, s7, 0x20000
    s_add_u32 s10, s10, s13
    s_add_u32 s10, s10, s42
    s_cmp_lt_u32 s7, 0x40000
    s_cselect_b32 s10, s10, 0x7f000000
    s_add_u32 m0, s9, 0x8000
    s_add_u32 s7, s7, 16384
    buffer_load_dwordx4 v237, s[48:51], s10 offen nt lds
    s_add_u32 m0, s9, 0x9000
    s_add_u32 s10, s10, 4096
    buffer_load_dwordx4 v237, s[48:51], s10 offen nt lds
    s_add_u32 m0, s9, 0xa000
    s_add_u32 s10, s10, 4096
    buffer_load_dwordx4 v237, s[48:51], s10 offen nt lds
    s_add_u32 m0, s9, 0xb000
    s_add_u32 s10, s10, 4096
    buffer_load_dwordx4 v237, s[48:51], s10 offen nt lds
    s_branch L_e_20
L_w_19:
    s_add_u32 m0, s9, 0x8000
    s_add_u32 s10, s74, 0x0
    buffer_load_dwordx4 v239, s[56:59], s10 offen lds
    s_add_u32 m0, s9, 0x9000
    s_add_u32 s10, s74, 0x20000
    buffer_load_dwordx4 v239, s[56:59], s10 offen lds
    s_add_u32 m0, s76, 0x8000
    s_add_u32 s74, s74, 0x40000
    buffer_load_dwordx4 v240, s[44:47], s75 offen lds
    s_add_u32 m0, s76, 0x8400
    s_nop 0
    buffer_load_dwordx4 v212, s[44:47], s75 offen lds
    s_add_u32 m0, s77, 0x800
    s_mov_b64 exec, 0xffff
    buffer_load_dwordx4 v241, s[44:47], s75 offen lds
    s_mov_b64 exec, -1
    s_add_u32 s75, s75, 64
L_e_20:
    v_xor_b32 v247, 64, v235
    v_xor_b32 v248, 128, v235
    v_xor_b32 v249, 192, v235
    ds_read_b64_tr_b16 v[192:193], v230 offset:49152
    ds_read_b64_tr_b16 v[194:195], v230 offset:50176
    ds_read_b64_tr_b16 v[196:197], v231 offset:49152
    ds_read_b64_tr_b16 v[198:199], v231 offset:50176
    ds_read_b64_tr_b16 v[200:201], v232 offset:49152
    ds_read_b64_tr_b16 v[202:203], v232 offset:50176
    ds_read_b64_tr_b16 v[204:205], v233 offset:49152
    ds_read_b64_tr_b16 v[206:207], v233 offset:50176
    s_waitcnt lgkmcnt(6)
    v_mfma_f32_32x32x16_bf16 v[0:15], v[192:195], v[176:179], v[0:15]
    ds_read_b64_tr_b16 v[208:209], v235 offset:49152
    ds_read_b64_tr_b16 v[210:211], v235 offset:49160
    s_waitcnt lgkmcnt(6)
    v_mfma_f32_32x32x16_bf16 v[16:31], v[196:199], v[176:179], v[16:31]
    ds_read_b64_tr_b16 v[192:193], v230 offset:53248
    ds_read_b64_tr_b16 v[194:195], v230 offset:54272
    s_waitcnt lgkmcnt(6)
    v_mfma_f32_32x32x16_bf16 v[32:47], v[200:203], v[176:179], v[32:47]
    ds_read_b64_tr_b16 v[196:197], v231 offset:53248
    ds_read_b64_tr_b16 v[198:199], v231 offset:54272
    s_waitcnt lgkmcnt(6)
    v_mfma_f32_32x32x16_bf16 v[48:63], v[204:207], v[176:179], v[48:63]
    ds_read_b64_tr_b16 v[200:201], v232 offset:53248
    ds_read_b64_tr_b16 v[202:203], v232 offset:54272
    s_waitcnt lgkmcnt(6)
    v_mfma_f32_16x16x16_bf16 v[64:67], v[208:209], v[220:221], v[64:67]
    v_mfma_f32_16x16x16_bf16 v[68:71], v[210:211], v[220:221], v[68:71]
    ds_read_b64_tr_b16 v[204:205], v233 offset:53248
    ds_read_b64_tr_b16 v[206:207], v233 offset:54272
    s_waitcnt lgkmcnt(6)
    v_mfma_f32_32x32x16_bf16 v[0:15], v[192:195], v[180:183], v[0:15]
    ds_read_b64_tr_b16 v[208:209], v247 offset:49152
    ds_read_b64_tr_b16 v[210:211], v247 offset:49160
    s_waitcnt lgkmcnt(6)
    v_mfma_f32_32x32x16_bf16 v[16:31], v[196:199], v[180:183], v[16:31]
    ds_read_b64_tr_b16 v[192:193], v230 offset:57344
    ds_read_b64_tr_b16 v[194:195], v230 offset:58368
    s_waitcnt lgkmcnt(6)
    v_mfma_f32_32x32x16_bf16 v[32:47], v[200:203], v[180:183], v[32:47]
    ds_read_b64_tr_b16 v[196:197], v231 offset:57344
    ds_read_b64_tr_b16 v[198:199], v231 offset:58368
    s_waitcnt lgkmcnt(6)
    v_mfma_f32_32x32x16_bf16 v[48:63], v[204:207], v[180:183], v[48:63]
    ds_read_b64_tr_b16 v[200:201], v232 offset:57344
    ds_read_b64_tr_b16 v[202:203], v232 offset:58368
    s_waitcnt lgkmcnt(6)
    v_mfma_f32_16x16x16_bf16 v[72:75], v[208:209], v[220:221], v[72:75]
    v_mfma_f32_16x16x16_bf16 v[76:79], v[210:211], v[220:221], v[76:79]
    ds_read_b64_tr_b16 v[204:205], v233 offset:57344
    ds_read_b64_tr_b16 v[206:207], v233 offset:58368
    s_waitcnt lgkmcnt(6)
    v_mfma_f32_32x32x16_bf16 v[0:15], v[192:195], v[184:187], v[0:15]
    ds_read_b64_tr_b16 v[208:209], v248 offset:49152
    ds_read_b64_tr_b16 v[210:211], v248 offset:49160
    s_waitcnt lgkmcnt(6)
    v_mfma_f32_32x32x16_bf16 v[16:31], v[196:199], v[184:187], v[16:31]
    ds_read_b64_tr_b16 v[192:193], v230 offset:61440
    ds_read_b64_tr_b16 v[194:195], v230 offset:62464
    s_waitcnt lgkmcnt(6)
    v_mfma_f32_32x32x16_bf16 v[32:47], v[200:203], v[184:187], v[32:47]
    ds_read_b64_tr_b16 v[196:197], v231 offset:61440
    ds_read_b64_tr_b16 v[198:199], v231 offset:62464
    s_waitcnt lgkmcnt(6)
    v_mfma_f32_32x32x16_bf16 v[48:63], v[204:207], v[184:187], v[48:63]
    ds_read_b64_tr_b16 v[200:201], v232 offset:61440
    ds_read_b64_tr_b16 v[202:203], v232 offset:62464
    s_waitcnt lgkmcnt(6)
    v_mfma_f32_16x16x16_bf16 v[80:83], v[208:209], v[220:221], v[80:83]
    v_mfma_f32_16x16x16_bf16 v[84:87], v[210:211], v[220:221], v[84:87]
    ds_read_b64_tr_b16 v[204:205], v233 offset:61440
    ds_read_b64_tr_b16 v[206:207], v233 offset:62464
    s_waitcnt lgkmcnt(6)
    v_mfma_f32_32x32x16_bf16 v[0:15], v[192:195], v[188:191], v[0:15]
    ds_read_b64_tr_b16 v[208:209], v249 offset:49152
    ds_read_b64_tr_b16 v[210:211], v249 offset:49160
    s_waitcnt lgkmcnt(6)
    v_mfma_f32_32x32x16_bf16 v[16:31], v[196:199], v[188:191], v[16:31]
    s_waitcnt lgkmcnt(4)
    v_mfma_f32_32x32x16_bf16 v[32:47], v[200:203], v[188:191], v[32:47]
    s_waitcnt lgkmcnt(2)
    v_mfma_f32_32x32x16_bf16 v[48:63], v[204:207], v[188:191], v[48:63]
    s_waitcnt lgkmcnt(0)
    v_mfma_f32_16x16x16_bf16 v[88:91], v[208:209], v[220:221], v[88:91]
    v_mfma_f32_16x16x16_bf16 v[92:95], v[210:211], v[220:221], v[92:95]
    s_mov_b32 s29, s43
    s_add_u32 s43, s43, 36864
    s_cmp_eq_u32 s78, 1
    s_cbranch_scc0 L_k1_nounpark
    buffer_load_dwordx4 v[96:99], v255, s[80:83], s84 offen offset:0 sc1
    buffer_load_dwordx4 v[100:103], v255, s[80:83], s84 offen offset:1024 sc1
    buffer_load_dwordx4 v[104:107], v255, s[80:83], s84 offen offset:2048 sc1
    buffer_load_dwordx4 v[108:111], v255, s[80:83], s84 offen offset:3072 sc1
    buffer_load_dwordx4 v[112:115], v255, s[80:83], s85 offen offset:0 sc1
    buffer_load_dwordx4 v[116:119], v255, s[80:83], s85 offen offset:1024 sc1
    buffer_load_dwordx4 v[120:123], v255, s[80:83], s85 offen offset:2048 sc1
    buffer_load_dwordx4 v[124:127], v255, s[80:83], s85 offen offset:3072 sc1
    buffer_load_dwordx4 v[128:131], v255, s[80:83], s86 offen offset:0 sc1
    buffer_load_dwordx4 v[132:135], v255, s[80:83], s86 offen offset:1024 sc1
    buffer_load_dwordx4 v[136:139], v255, s[80:83], s86 offen offset:2048 sc1
    buffer_load_dwordx4 v[140:143], v255, s[80:83], s86 offen offset:3072 sc1
L_k1_nounpark:
    v_mov_b32 v246, v243
    v_mov_b32 v247, v245
    s_nop 1
    v_permlane32_swap_b32 v243, v246
    v_permlane32_swap_b32 v245, v247
    s_nop 1
    v_add_f32 v243, v243, v246
    v_add_f32 v245, v245, v247
    v_mov_b32 v247, v245
    v_rcp_f32 v243, v243
    s_nop 1
    v_permlane16_swap_b32 v245, v247
    s_nop 1
    v_add_f32 v245, v245, v247
    v_lshrrev_b32 v248, 1, v255
    v_add_u32 v248, 0x10000, v248
    s_lshl_b32 s10, s3, 9
    v_add_u32 v247, s10, v248
    ds_write_b64 v247, v[244:245]
    s_lshl_b32 s15, s3, 11
    s_add_u32 s15, s15, s29
    v_mul_f32 v0, v0, v243
    v_mul_f32 v1, v1, v243
    v_mul_f32 v2, v2, v243
    v_mul_f32 v3, v3, v243
    v_mul_f32 v4, v4, v243
    v_mul_f32 v5, v5, v243
    v_mul_f32 v6, v6, v243
    v_mul_f32 v7, v7, v243
    v_mul_f32 v8, v8, v243
    v_mul_f32 v9, v9, v243
    v_mul_f32 v10, v10, v243
    v_mul_f32 v11, v11, v243
    v_mul_f32 v12, v12, v243
    v_mul_f32 v13, v13, v243
    v_mul_f32 v14, v14, v243
    v_mul_f32 v15, v15, v243
    v_mul_f32 v16, v16, v243
    v_mul_f32 v17, v17, v243
    v_mul_f32 v18, v18, v243
    v_mul_f32 v19, v19, v243
    v_mul_f32 v20, v20, v243
    v_mul_f32 v21, v21, v243
    v_mul_f32 v22, v22, v243
    v_mul_f32 v23, v23, v243
    v_mul_f32 v24, v24, v243
    v_mul_f32 v25, v25, v243
    v_mul_f32 v26, v26, v243
    v_mul_f32 v27, v27, v243
    v_mul_f32 v28, v28, v243
    v_mul_f32 v29, v29, v243
    v_mul_f32 v30, v30, v243
    v_mul_f32 v31, v31, v243
    v_mul_f32 v32, v32, v243
    v_mul_f32 v33, v33, v243
    v_mul_f32 v34, v34, v243
    v_mul_f32 v35, v35, v243
    v_mul_f32 v36, v36, v243
    v_mul_f32 v37, v37, v243
    v_mul_f32 v38, v38, v243
    v_mul_f32 v39, v39, v243
    v_mul_f32 v40, v40, v243
    v_mul_f32 v41, v41, v243
    v_mul_f32 v42, v42, v243
    v_mul_f32 v43, v43, v243
    v_mul_f32 v44, v44, v243
    v_mul_f32 v45, v45, v243
    v_mul_f32 v46, v46, v243
    v_mul_f32 v47, v47, v243
    v_mul_f32 v48, v48, v243
    v_mul_f32 v49, v49, v243
    v_mul_f32 v50, v50, v243
    v_mul_f32 v51, v51, v243
    v_mul_f32 v52, v52, v243
    v_mul_f32 v53, v53, v243
    v_mul_f32 v54, v54, v243
    v_mul_f32 v55, v55, v243
    v_mul_f32 v56, v56, v243
    v_mul_f32 v57, v57, v243
    v_mul_f32 v58, v58, v243
    v_mul_f32 v59, v59, v243
    v_mul_f32 v60, v60, v243
    v_mul_f32 v61, v61, v243
    v_mul_f32 v62, v62, v243
    v_mul_f32 v63, v63, v243
    v_cvt_pk_bf16_f32 v0, v0, v1
    v_cvt_pk_bf16_f32 v1, v2, v3
    v_cvt_pk_bf16_f32 v2, v4, v5
    v_cvt_pk_bf16_f32 v3, v6, v7
    v_cvt_pk_bf16_f32 v4, v8, v9
    v_cvt_pk_bf16_f32 v5, v10, v11
    v_cvt_pk_bf16_f32 v6, v12, v13
    v_cvt_pk_bf16_f32 v7, v14, v15
    v_cvt_pk_bf16_f32 v8, v16, v17
    v_cvt_pk_bf16_f32 v9, v18, v19
    v_cvt_pk_bf16_f32 v10, v20, v21
    v_cvt_pk_bf16_f32 v11, v22, v23
    v_cvt_pk_bf16_f32 v12, v24, v25
    v_cvt_pk_bf16_f32 v13, v26, v27
    v_cvt_pk_bf16_f32 v14, v28, v29
    v_cvt_pk_bf16_f32 v15, v30, v31
    v_cvt_pk_bf16_f32 v16, v32, v33
    v_cvt_pk_bf16_f32 v17, v34, v35
    v_cvt_pk_bf16_f32 v18, v36, v37
    v_cvt_pk_bf16_f32 v19, v38, v39
    v_cvt_pk_bf16_f32 v20, v40, v41
    v_cvt_pk_bf16_f32 v21, v42, v43
    v_cvt_pk_bf16_f32 v22, v44, v45
    v_cvt_pk_bf16_f32 v23, v46, v47
    v_cvt_pk_bf16_f32 v24, v48, v49
    v_cvt_pk_bf16_f32 v25, v50, v51
    v_cvt_pk_bf16_f32 v26, v52, v53
    v_cvt_pk_bf16_f32 v27, v54, v55
    v_cvt_pk_bf16_f32 v28, v56, v57
    v_cvt_pk_bf16_f32 v29, v58, v59
    v_cvt_pk_bf16_f32 v30, v60, v61
    v_cvt_pk_bf16_f32 v31, v62, v63
    buffer_store_dwordx4 v[0:3], v236, s[64:67], s15 offen offset:0 sc0 sc1
    buffer_store_dwordx4 v[4:7], v236, s[64:67], s15 offen offset:512 sc0 sc1
    s_add_u32 s15, s15, 9216
    buffer_store_dwordx4 v[8:11], v236, s[64:67], s15 offen offset:0 sc0 sc1
    buffer_store_dwordx4 v[12:15], v236, s[64:67], s15 offen offset:512 sc0 sc1
    s_add_u32 s15, s15, 9216
    buffer_store_dwordx4 v[16:19], v236, s[64:67], s15 offen offset:0 sc0 sc1
    buffer_store_dwordx4 v[20:23], v236, s[64:67], s15 offen offset:512 sc0 sc1
    s_add_u32 s15, s15, 9216
    buffer_store_dwordx4 v[24:27], v236, s[64:67], s15 offen offset:0 sc0 sc1
    buffer_store_dwordx4 v[28:31], v236, s[64:67], s15 offen offset:512 sc0 sc1
    s_waitcnt lgkmcnt(0)
    s_barrier
    ds_read_b64 v[192:193], v248 offset:0
    ds_read_b64 v[194:195], v248 offset:512
    ds_read_b64 v[196:197], v248 offset:1024
    ds_read_b64 v[198:199], v248 offset:1536
    s_waitcnt lgkmcnt(0)
    s_barrier
    v_max3_f32 v247, v192, v194, v196
    v_max_f32 v247, v247, v198
    v_sub_f32 v192, v192, v247
    v_sub_f32 v194, v194, v247
    v_sub_f32 v196, v196, v247
    v_sub_f32 v198, v198, v247
    v_sub_f32 v249, v244, v247
    v_exp_f32 v192, v192
    v_exp_f32 v194, v194
    v_exp_f32 v196, v196
    v_exp_f32 v198, v198
    v_exp_f32 v249, v249
    v_mul_f32 v247, v192, v193
    v_fmac_f32 v247, v194, v195
    v_fmac_f32 v247, v196, v197
    v_fmac_f32 v247, v198, v199
    v_rcp_f32 v247, v247
    s_nop 0
    v_mul_f32 v249, v249, v247
    v_mul_f32 v64, v64, v249
    v_mul_f32 v65, v65, v249
    v_mul_f32 v66, v66, v249
    v_mul_f32 v67, v67, v249
    v_mul_f32 v68, v68, v249
    v_mul_f32 v69, v69, v249
    v_mul_f32 v70, v70, v249
    v_mul_f32 v71, v71, v249
    v_mul_f32 v72, v72, v249
    v_mul_f32 v73, v73, v249
    v_mul_f32 v74, v74, v249
    v_mul_f32 v75, v75, v249
    v_mul_f32 v76, v76, v249
    v_mul_f32 v77, v77, v249
    v_mul_f32 v78, v78, v249
    v_mul_f32 v79, v79, v249
    v_mul_f32 v80, v80, v249
    v_mul_f32 v81, v81, v249
    v_mul_f32 v82, v82, v249
    v_mul_f32 v83, v83, v249
    v_mul_f32 v84, v84, v249
    v_mul_f32 v85, v85, v249
    v_mul_f32 v86, v86, v249
    v_mul_f32 v87, v87, v249
    v_mul_f32 v88, v88, v249
    v_mul_f32 v89, v89, v249
    v_mul_f32 v90, v90, v249
    v_mul_f32 v91, v91, v249
    v_mul_f32 v92, v92, v249
    v_mul_f32 v93, v93, v249
    v_mul_f32 v94, v94, v249
    v_mul_f32 v95, v95, v249
    s_lshl_b32 s10, s3, 12
    s_add_u32 s10, s10, 49152
    v_add_u32 v246, s10, v255
    s_and_b32 s10, s3, 1
    s_lshl_b32 s10, s10, 11
    s_add_u32 s10, s10, 49152
    v_add_u32 v247, s10, v255
    s_mul_i32 s15, s3, 9216
    s_add_u32 s15, s15, s29
    s_add_u32 s15, s15, 8192
    s_lshr_b32 s14, s3, 1
    ds_write_b128 v246, v[64:67] offset:0
    ds_write_b128 v246, v[68:71] offset:1024
    ds_write_b128 v246, v[72:75] offset:2048
    ds_write_b128 v246, v[76:79] offset:3072
    s_waitcnt lgkmcnt(0)
    s_barrier
    ds_read_b128 v[144:147], v247 offset:0
    ds_read_b128 v[148:151], v247 offset:1024
    ds_read_b128 v[152:155], v247 offset:4096
    ds_read_b128 v[156:159], v247 offset:5120
    ds_read_b128 v[160:163], v247 offset:8192
    ds_read_b128 v[164:167], v247 offset:9216
    ds_read_b128 v[168:171], v247 offset:12288
    ds_read_b128 v[172:175], v247 offset:13312
    s_waitcnt lgkmcnt(0)
    v_add_f32 v144, v144, v152
    v_add_f32 v160, v160, v168
    v_add_f32 v145, v145, v153
    v_add_f32 v161, v161, v169
    v_add_f32 v146, v146, v154
    v_add_f32 v162, v162, v170
    v_add_f32 v147, v147, v155
    v_add_f32 v163, v163, v171
    v_add_f32 v148, v148, v156
    v_add_f32 v164, v164, v172
    v_add_f32 v149, v149, v157
    v_add_f32 v165, v165, v173
    v_add_f32 v150, v150, v158
    v_add_f32 v166, v166, v174
    v_add_f32 v151, v151, v159
    v_add_f32 v167, v167, v175
    v_add_f32 v144, v144, v160
    v_add_f32 v145, v145, v161
    v_add_f32 v146, v146, v162
    v_add_f32 v147, v147, v163
    v_add_f32 v148, v148, v164
    v_add_f32 v149, v149, v165
    v_add_f32 v150, v150, v166
    v_add_f32 v151, v151, v167
    v_cvt_pk_bf16_f32 v176, v144, v145
    v_cvt_pk_bf16_f32 v177, v146, v147
    v_cvt_pk_bf16_f32 v178, v148, v149
    v_cvt_pk_bf16_f32 v179, v150, v151
    s_cmp_eq_u32 s14, 0
    s_cselect_b32 s16, s15, 0x7f000000
    buffer_store_dwordx4 v[176:179], v255, s[64:67], s16 offen sc0 sc1
    s_barrier
    ds_write_b128 v246, v[80:83] offset:0
    ds_write_b128 v246, v[84:87] offset:1024
    ds_write_b128 v246, v[88:91] offset:2048
    ds_write_b128 v246, v[92:95] offset:3072
    s_waitcnt lgkmcnt(0)
    s_barrier
    ds_read_b128 v[144:147], v247 offset:0
    ds_read_b128 v[148:151], v247 offset:1024
    ds_read_b128 v[152:155], v247 offset:4096
    ds_read_b128 v[156:159], v247 offset:5120
    ds_read_b128 v[160:163], v247 offset:8192
    ds_read_b128 v[164:167], v247 offset:9216
    ds_read_b128 v[168:171], v247 offset:12288
    ds_read_b128 v[172:175], v247 offset:13312
    s_waitcnt lgkmcnt(0)
    v_add_f32 v144, v144, v152
    v_add_f32 v160, v160, v168
    v_add_f32 v145, v145, v153
    v_add_f32 v161, v161, v169
    v_add_f32 v146, v146, v154
    v_add_f32 v162, v162, v170
    v_add_f32 v147, v147, v155
    v_add_f32 v163, v163, v171
    v_add_f32 v148, v148, v156
    v_add_f32 v164, v164, v172
    v_add_f32 v149, v149, v157
    v_add_f32 v165, v165, v173
    v_add_f32 v150, v150, v158
    v_add_f32 v166, v166, v174
    v_add_f32 v151, v151, v159
    v_add_f32 v167, v167, v175
    v_add_f32 v144, v144, v160
    v_add_f32 v145, v145, v161
    v_add_f32 v146, v146, v162
    v_add_f32 v147, v147, v163
    v_add_f32 v148, v148, v164
    v_add_f32 v149, v149, v165
    v_add_f32 v150, v150, v166
    v_add_f32 v151, v151, v167
    v_cvt_pk_bf16_f32 v180, v144, v145
    v_cvt_pk_bf16_f32 v181, v146, v147
    v_cvt_pk_bf16_f32 v182, v148, v149
    v_cvt_pk_bf16_f32 v183, v150, v151
    s_cmp_eq_u32 s14, 1
    s_cselect_b32 s16, s15, 0x7f000000
    buffer_store_dwordx4 v[180:183], v255, s[64:67], s16 offen sc0 sc1
    s_add_u32 s28, s28, 1
    s_cmp_lt_u32 s28, 2
    s_cbranch_scc0 L_k1_end
    s_cmp_eq_u32 s78, 0
    s_cbranch_scc1 L_k1_head
    s_waitcnt vmcnt(10)
    s_branch L_k1_att
L_k1_end:
    s_endpgm
.globl oproj_kernel
.p2align 8
.type oproj_kernel,@function
oproj_kernel:
    s_cmp_ge_u32 s2, 256
    s_cbranch_scc1 L_k2_end
    s_load_dwordx2 s[36:37], s[0:1], 80
    s_load_dwordx2 s[40:41], s[0:1], 96
    v_lshrrev_b32 v1, 6, v0
    v_and_b32 v2, 63, v0
    s_nop 0
    v_readfirstlane_b32 s3, v1
    s_and_b32 s8, s2, 7
    s_lshr_b32 s9, s2, 3
    s_lshr_b32 s4, s8, 2
    s_and_b32 s5, s8, 3
    s_lshl_b32 s5, s5, 2
    s_lshr_b32 s10, s9, 3
    s_add_u32 s5, s5, s10
    s_and_b32 s6, s9, 7
    v_lshlrev_b32 v3, 4, v2
    s_lshl_b32 s10, s4, 4
    s_add_u32 s10, s10, s5
    s_lshl_b32 s10, s10, 2
    s_add_u32 s10, s10, s3
    s_mul_i32 s10, s10, 294912
    v_add_u32 v4, s10, v3
    s_lshl_b32 s10, s4, 3
    s_add_u32 s10, s10, s6
    s_lshl_b32 s10, s10, 2
    s_add_u32 s10, s10, s3
    s_mul_i32 s10, s10, 163840
    v_add_u32 v5, s10, v3
    s_mov_b32 s22, 0
    s_waitcnt lgkmcnt(0)
    s_mov_b32 s44, s40
    s_and_b32 s45, s41, 0xffff
    s_mov_b32 s46, 0x2400000
    s_mov_b32 s47, 0x20000
    s_add_u32 s40, s40, 0x2400000
    s_addc_u32 s41, s41, 0
    s_mov_b32 s48, s40
    s_and_b32 s49, s41, 0xffff
    s_mov_b32 s50, 0xa00000
    s_mov_b32 s51, 0x20000
    s_mov_b32 s52, s36
    s_and_b32 s53, s37, 0xffff
    s_mov_b32 s54, 0x5a0000
    s_mov_b32 s55, 0x20000
    s_mul_i32 s16, s22, 5120
    s_mul_i32 s18, s22, 9216
    s_cmp_lt_u32 s22, 32
    s_cselect_b32 s16, s16, 0x7f000000
    s_cselect_b32 s18, s18, 0x7f000000
    s_add_u32 s17, s16, 4096
    s_add_u32 s19, s18, 4096
    s_add_u32 s20, s18, 8192
    s_add_u32 s22, s22, 1
    buffer_load_dwordx4 v[8:11], v5, s[48:51], s16 offen offset:0
    buffer_load_dwordx4 v[12:15], v5, s[48:51], s16 offen offset:1024
    buffer_load_dwordx4 v[16:19], v5, s[48:51], s16 offen offset:2048
    buffer_load_dwordx4 v[20:23], v5, s[48:51], s16 offen offset:3072
    buffer_load_dwordx4 v[24:27], v5, s[48:51], s17 offen offset:0
    buffer_load_dwordx4 v[28:31], v4, s[44:47], s18 offen offset:0
    buffer_load_dwordx4 v[32:35], v4, s[44:47], s18 offen offset:1024
    buffer_load_dwordx4 v[36:39], v4, s[44:47], s18 offen offset:2048
    buffer_load_dwordx4 v[40:43], v4, s[44:47], s18 offen offset:3072
    buffer_load_dwordx4 v[44:47], v4, s[44:47], s19 offen offset:0
    buffer_load_dwordx4 v[48:51], v4, s[44:47], s19 offen offset:1024
    buffer_load_dwordx4 v[52:55], v4, s[44:47], s19 offen offset:2048
    buffer_load_dwordx4 v[56:59], v4, s[44:47], s19 offen offset:3072
    buffer_load_dwordx4 v[60:63], v4, s[44:47], s20 offen offset:0
    s_mul_i32 s16, s22, 5120
    s_mul_i32 s18, s22, 9216
    s_cmp_lt_u32 s22, 32
    s_cselect_b32 s16, s16, 0x7f000000
    s_cselect_b32 s18, s18, 0x7f000000
    s_add_u32 s17, s16, 4096
    s_add_u32 s19, s18, 4096
    s_add_u32 s20, s18, 8192
    s_add_u32 s22, s22, 1
    buffer_load_dwordx4 v[64:67], v5, s[48:51], s16 offen offset:0
    buffer_load_dwordx4 v[68:71], v5, s[48:51], s16 offen offset:1024
    buffer_load_dwordx4 v[72:75], v5, s[48:51], s16 offen offset:2048
    buffer_load_dwordx4 v[76:79], v5, s[48:51], s16 offen offset:3072
    buffer_load_dwordx4 v[80:83], v5, s[48:51], s17 offen offset:0
    buffer_load_dwordx4 v[84:87], v4, s[44:47], s18 offen offset:0
    buffer_load_dwordx4 v[88:91], v4, s[44:47], s18 offen offset:1024
    buffer_load_dwordx4 v[92:95], v4, s[44:47], s18 offen offset:2048
    buffer_load_dwordx4 v[96:99], v4, s[44:47], s18 offen offset:3072
    buffer_load_dwordx4 v[100:103], v4, s[44:47], s19 offen offset:0
    buffer_load_dwordx4 v[104:107], v4, s[44:47], s19 offen offset:1024
    buffer_load_dwordx4 v[108:111], v4, s[44:47], s19 offen offset:2048
    buffer_load_dwordx4 v[112:115], v4, s[44:47], s19 offen offset:3072
    buffer_load_dwordx4 v[116:119], v4, s[44:47], s20 offen offset:0
    s_mul_i32 s16, s22, 5120
    s_mul_i32 s18, s22, 9216
    s_cmp_lt_u32 s22, 32
    s_cselect_b32 s16, s16, 0x7f000000
    s_cselect_b32 s18, s18, 0x7f000000
    s_add_u32 s17, s16, 4096
    s_add_u32 s19, s18, 4096
    s_add_u32 s20, s18, 8192
    s_add_u32 s22, s22, 1
    buffer_load_dwordx4 v[120:123], v5, s[48:51], s16 offen offset:0
    buffer_load_dwordx4 v[124:127], v5, s[48:51], s16 offen offset:1024
    buffer_load_dwordx4 v[128:131], v5, s[48:51], s16 offen offset:2048
    buffer_load_dwordx4 v[132:135], v5, s[48:51], s16 offen offset:3072
    buffer_load_dwordx4 v[136:139], v5, s[48:51], s17 offen offset:0
    buffer_load_dwordx4 v[140:143], v4, s[44:47], s18 offen offset:0
    buffer_load_dwordx4 v[144:147], v4, s[44:47], s18 offen offset:1024
    buffer_load_dwordx4 v[148:151], v4, s[44:47], s18 offen offset:2048
    buffer_load_dwordx4 v[152:155], v4, s[44:47], s18 offen offset:3072
    buffer_load_dwordx4 v[156:159], v4, s[44:47], s19 offen offset:0
    buffer_load_dwordx4 v[160:163], v4, s[44:47], s19 offen offset:1024
    buffer_load_dwordx4 v[164:167], v4, s[44:47], s19 offen offset:2048
    buffer_load_dwordx4 v[168:171], v4, s[44:47], s19 offen offset:3072
    buffer_load_dwordx4 v[172:175], v4, s[44:47], s20 offen offset:0
    v_accvgpr_write_b32 a0, 0
    v_accvgpr_write_b32 a1, 0
    v_accvgpr_write_b32 a2, 0
    v_accvgpr_write_b32 a3, 0
    v_accvgpr_write_b32 a4, 0
    v_accvgpr_write_b32 a5, 0
    v_accvgpr_write_b32 a6, 0
    v_accvgpr_write_b32 a7, 0
    v_accvgpr_write_b32 a8, 0
    v_accvgpr_write_b32 a9, 0
    v_accvgpr_write_b32 a10, 0
    v_accvgpr_write_b32 a11, 0
    v_accvgpr_write_b32 a12, 0
    v_accvgpr_write_b32 a13, 0
    v_accvgpr_write_b32 a14, 0
    v_accvgpr_write_b32 a15, 0
    v_accvgpr_write_b32 a16, 0
    v_accvgpr_write_b32 a17, 0
    v_accvgpr_write_b32 a18, 0
    v_accvgpr_write_b32 a19, 0
    v_accvgpr_write_b32 a20, 0
    v_accvgpr_write_b32 a21, 0
    v_accvgpr_write_b32 a22, 0
    v_accvgpr_write_b32 a23, 0
    v_accvgpr_write_b32 a24, 0
    v_accvgpr_write_b32 a25, 0
    v_accvgpr_write_b32 a26, 0
    v_accvgpr_write_b32 a27, 0
    v_accvgpr_write_b32 a28, 0
    v_accvgpr_write_b32 a29, 0
    v_accvgpr_write_b32 a30, 0
    v_accvgpr_write_b32 a31, 0
    v_accvgpr_write_b32 a32, 0
    v_accvgpr_write_b32 a33, 0
    v_accvgpr_write_b32 a34, 0
    v_accvgpr_write_b32 a35, 0
    v_accvgpr_write_b32 a36, 0
    v_accvgpr_write_b32 a37, 0
    v_accvgpr_write_b32 a38, 0
    v_accvgpr_write_b32 a39, 0
    v_accvgpr_write_b32 a40, 0
    v_accvgpr_write_b32 a41, 0
    v_accvgpr_write_b32 a42, 0
    v_accvgpr_write_b32 a43, 0
    v_accvgpr_write_b32 a44, 0
    v_accvgpr_write_b32 a45, 0
    v_accvgpr_write_b32 a46, 0
    v_accvgpr_write_b32 a47, 0
    v_accvgpr_write_b32 a48, 0
    v_accvgpr_write_b32 a49, 0
    v_accvgpr_write_b32 a50, 0
    v_accvgpr_write_b32 a51, 0
    v_accvgpr_write_b32 a52, 0
    v_accvgpr_write_b32 a53, 0
    v_accvgpr_write_b32 a54, 0
    v_accvgpr_write_b32 a55, 0
    v_accvgpr_write_b32 a56, 0
    v_accvgpr_write_b32 a57, 0
    v_accvgpr_write_b32 a58, 0
    v_accvgpr_write_b32 a59, 0
    v_accvgpr_write_b32 a60, 0
    v_accvgpr_write_b32 a61, 0
    v_accvgpr_write_b32 a62, 0
    v_accvgpr_write_b32 a63, 0
    v_accvgpr_write_b32 a64, 0
    v_accvgpr_write_b32 a65, 0
    v_accvgpr_write_b32 a66, 0
    v_accvgpr_write_b32 a67, 0
    v_accvgpr_write_b32 a68, 0
    v_accvgpr_write_b32 a69, 0
    v_accvgpr_write_b32 a70, 0
    v_accvgpr_write_b32 a71, 0
    v_accvgpr_write_b32 a72, 0
    v_accvgpr_write_b32 a73, 0
    v_accvgpr_write_b32 a74, 0
    v_accvgpr_write_b32 a75, 0
    v_accvgpr_write_b32 a76, 0
    v_accvgpr_write_b32 a77, 0
    v_accvgpr_write_b32 a78, 0
    v_accvgpr_write_b32 a79, 0
    v_accvgpr_write_b32 a80, 0
    v_accvgpr_write_b32 a81, 0
    v_accvgpr_write_b32 a82, 0
    v_accvgpr_write_b32 a83, 0
    v_accvgpr_write_b32 a84, 0
    v_accvgpr_write_b32 a85, 0
    v_accvgpr_write_b32 a86, 0
    v_accvgpr_write_b32 a87, 0
    v_accvgpr_write_b32 a88, 0
    v_accvgpr_write_b32 a89, 0
    v_accvgpr_write_b32 a90, 0
    v_accvgpr_write_b32 a91, 0
    v_accvgpr_write_b32 a92, 0
    v_accvgpr_write_b32 a93, 0
    v_accvgpr_write_b32 a94, 0
    v_accvgpr_write_b32 a95, 0
    v_accvgpr_write_b32 a96, 0
    v_accvgpr_write_b32 a97, 0
    v_accvgpr_write_b32 a98, 0
    v_accvgpr_write_b32 a99, 0
    v_accvgpr_write_b32 a100, 0
    v_accvgpr_write_b32 a101, 0
    v_accvgpr_write_b32 a102, 0
    v_accvgpr_write_b32 a103, 0
    v_accvgpr_write_b32 a104, 0
    v_accvgpr_write_b32 a105, 0
    v_accvgpr_write_b32 a106, 0
    v_accvgpr_write_b32 a107, 0
    v_accvgpr_write_b32 a108, 0
    v_accvgpr_write_b32 a109, 0
    v_accvgpr_write_b32 a110, 0
    v_accvgpr_write_b32 a111, 0
    v_accvgpr_write_b32 a112, 0
    v_accvgpr_write_b32 a113, 0
    v_accvgpr_write_b32 a114, 0
    v_accvgpr_write_b32 a115, 0
    v_accvgpr_write_b32 a116, 0
    v_accvgpr_write_b32 a117, 0
    v_accvgpr_write_b32 a118, 0
    v_accvgpr_write_b32 a119, 0
    v_accvgpr_write_b32 a120, 0
    v_accvgpr_write_b32 a121, 0
    v_accvgpr_write_b32 a122, 0
    v_accvgpr_write_b32 a123, 0
    v_accvgpr_write_b32 a124, 0
    v_accvgpr_write_b32 a125, 0
    v_accvgpr_write_b32 a126, 0
    v_accvgpr_write_b32 a127, 0
    v_accvgpr_write_b32 a128, 0
    v_accvgpr_write_b32 a129, 0
    v_accvgpr_write_b32 a130, 0
    v_accvgpr_write_b32 a131, 0
    v_accvgpr_write_b32 a132, 0
    v_accvgpr_write_b32 a133, 0
    v_accvgpr_write_b32 a134, 0
    v_accvgpr_write_b32 a135, 0
    v_accvgpr_write_b32 a136, 0
    v_accvgpr_write_b32 a137, 0
    v_accvgpr_write_b32 a138, 0
    v_accvgpr_write_b32 a139, 0
    v_accvgpr_write_b32 a140, 0
    v_accvgpr_write_b32 a141, 0
    v_accvgpr_write_b32 a142, 0
    v_accvgpr_write_b32 a143, 0
    v_accvgpr_write_b32 a144, 0
    v_accvgpr_write_b32 a145, 0
    v_accvgpr_write_b32 a146, 0
    v_accvgpr_write_b32 a147, 0
    v_accvgpr_write_b32 a148, 0
    v_accvgpr_write_b32 a149, 0
    v_accvgpr_write_b32 a150, 0
    v_accvgpr_write_b32 a151, 0
    v_accvgpr_write_b32 a152, 0
    v_accvgpr_write_b32 a153, 0
    v_accvgpr_write_b32 a154, 0
    v_accvgpr_write_b32 a155, 0
    v_accvgpr_write_b32 a156, 0
    v_accvgpr_write_b32 a157, 0
    v_accvgpr_write_b32 a158, 0
    v_accvgpr_write_b32 a159, 0
    v_accvgpr_write_b32 a160, 0
    v_accvgpr_write_b32 a161, 0
    v_accvgpr_write_b32 a162, 0
    v_accvgpr_write_b32 a163, 0
    v_accvgpr_write_b32 a164, 0
    v_accvgpr_write_b32 a165, 0
    v_accvgpr_write_b32 a166, 0
    v_accvgpr_write_b32 a167, 0
    v_accvgpr_write_b32 a168, 0
    v_accvgpr_write_b32 a169, 0
    v_accvgpr_write_b32 a170, 0
    v_accvgpr_write_b32 a171, 0
    v_accvgpr_write_b32 a172, 0
    v_accvgpr_write_b32 a173, 0
    v_accvgpr_write_b32 a174, 0
    v_accvgpr_write_b32 a175, 0
    v_accvgpr_write_b32 a176, 0
    v_accvgpr_write_b32 a177, 0
    v_accvgpr_write_b32 a178, 0
    v_accvgpr_write_b32 a179, 0
L_k2_loop:
    s_mul_i32 s16, s22, 5120
    s_mul_i32 s18, s22, 9216
    s_cmp_lt_u32 s22, 32
    s_cselect_b32 s16, s16, 0x7f000000
    s_cselect_b32 s18, s18, 0x7f000000
    s_add_u32 s17, s16, 4096
    s_add_u32 s19, s18, 4096
    s_add_u32 s20, s18, 8192
    s_add_u32 s22, s22, 1
    buffer_load_dwordx4 v[176:179], v5, s[48:51], s16 offen offset:0
    buffer_load_dwordx4 v[180:183], v5, s[48:51], s16 offen offset:1024
    buffer_load_dwordx4 v[184:187], v5, s[48:51], s16 offen offset:2048
    buffer_load_dwordx4 v[188:191], v5, s[48:51], s16 offen offset:3072
    buffer_load_dwordx4 v[192:195], v5, s[48:51], s17 offen offset:0
    buffer_load_dwordx4 v[196:199], v4, s[44:47], s18 offen offset:0
    buffer_load_dwordx4 v[200:203], v4, s[44:47], s18 offen offset:1024
    buffer_load_dwordx4 v[204:207], v4, s[44:47], s18 offen offset:2048
    buffer_load_dwordx4 v[208:211], v4, s[44:47], s18 offen offset:3072
    buffer_load_dwordx4 v[212:215], v4, s[44:47], s19 offen offset:0
    buffer_load_dwordx4 v[216:219], v4, s[44:47], s19 offen offset:1024
    buffer_load_dwordx4 v[220:223], v4, s[44:47], s19 offen offset:2048
    buffer_load_dwordx4 v[224:227], v4, s[44:47], s19 offen offset:3072
    buffer_load_dwordx4 v[228:231], v4, s[44:47], s20 offen offset:0
    s_waitcnt vmcnt(42)
    v_mfma_f32_16x16x32_bf16 a[0:3], v[8:11], v[28:31], a[0:3]
    v_mfma_f32_16x16x32_bf16 a[36:39], v[12:15], v[28:31], a[36:39]
    v_mfma_f32_16x16x32_bf16 a[72:75], v[16:19], v[28:31], a[72:75]
    v_mfma_f32_16x16x32_bf16 a[108:111], v[20:23], v[28:31], a[108:111]
    v_mfma_f32_16x16x32_bf16 a[144:147], v[24:27], v[28:31], a[144:147]
    v_mfma_f32_16x16x32_bf16 a[4:7], v[8:11], v[32:35], a[4:7]
    v_mfma_f32_16x16x32_bf16 a[40:43], v[12:15], v[32:35], a[40:43]
    v_mfma_f32_16x16x32_bf16 a[76:79], v[16:19], v[32:35], a[76:79]
    v_mfma_f32_16x16x32_bf16 a[112:115], v[20:23], v[32:35], a[112:115]
    v_mfma_f32_16x16x32_bf16 a[148:151], v[24:27], v[32:35], a[148:151]
    v_mfma_f32_16x16x32_bf16 a[8:11], v[8:11], v[36:39], a[8:11]
    v_mfma_f32_16x16x32_bf16 a[44:47], v[12:15], v[36:39], a[44:47]
    v_mfma_f32_16x16x32_bf16 a[80:83], v[16:19], v[36:39], a[80:83]
    v_mfma_f32_16x16x32_bf16 a[116:119], v[20:23], v[36:39], a[116:119]
    v_mfma_f32_16x16x32_bf16 a[152:155], v[24:27], v[36:39], a[152:155]
    v_mfma_f32_16x16x32_bf16 a[12:15], v[8:11], v[40:43], a[12:15]
    v_mfma_f32_16x16x32_bf16 a[48:51], v[12:15], v[40:43], a[48:51]
    v_mfma_f32_16x16x32_bf16 a[84:87], v[16:19], v[40:43], a[84:87]
    v_mfma_f32_16x16x32_bf16 a[120:123], v[20:23], v[40:43], a[120:123]
    v_mfma_f32_16x16x32_bf16 a[156:159], v[24:27], v[40:43], a[156:159]
    v_mfma_f32_16x16x32_bf16 a[16:19], v[8:11], v[44:47], a[16:19]
    v_mfma_f32_16x16x32_bf16 a[52:55], v[12:15], v[44:47], a[52:55]
    v_mfma_f32_16x16x32_bf16 a[88:91], v[16:19], v[44:47], a[88:91]
    v_mfma_f32_16x16x32_bf16 a[124:127], v[20:23], v[44:47], a[124:127]
    v_mfma_f32_16x16x32_bf16 a[160:163], v[24:27], v[44:47], a[160:163]
    v_mfma_f32_16x16x32_bf16 a[20:23], v[8:11], v[48:51], a[20:23]
    v_mfma_f32_16x16x32_bf16 a[56:59], v[12:15], v[48:51], a[56:59]
    v_mfma_f32_16x16x32_bf16 a[92:95], v[16:19], v[48:51], a[92:95]
    v_mfma_f32_16x16x32_bf16 a[128:131], v[20:23], v[48:51], a[128:131]
    v_mfma_f32_16x16x32_bf16 a[164:167], v[24:27], v[48:51], a[164:167]
    v_mfma_f32_16x16x32_bf16 a[24:27], v[8:11], v[52:55], a[24:27]
    v_mfma_f32_16x16x32_bf16 a[60:63], v[12:15], v[52:55], a[60:63]
    v_mfma_f32_16x16x32_bf16 a[96:99], v[16:19], v[52:55], a[96:99]
    v_mfma_f32_16x16x32_bf16 a[132:135], v[20:23], v[52:55], a[132:135]
    v_mfma_f32_16x16x32_bf16 a[168:171], v[24:27], v[52:55], a[168:171]
    v_mfma_f32_16x16x32_bf16 a[28:31], v[8:11], v[56:59], a[28:31]
    v_mfma_f32_16x16x32_bf16 a[64:67], v[12:15], v[56:59], a[64:67]
    v_mfma_f32_16x16x32_bf16 a[100:103], v[16:19], v[56:59], a[100:103]
    v_mfma_f32_16x16x32_bf16 a[136:139], v[20:23], v[56:59], a[136:139]
    v_mfma_f32_16x16x32_bf16 a[172:175], v[24:27], v[56:59], a[172:175]
    v_mfma_f32_16x16x32_bf16 a[32:35], v[8:11], v[60:63], a[32:35]
    v_mfma_f32_16x16x32_bf16 a[68:71], v[12:15], v[60:63], a[68:71]
    v_mfma_f32_16x16x32_bf16 a[104:107], v[16:19], v[60:63], a[104:107]
    v_mfma_f32_16x16x32_bf16 a[140:143], v[20:23], v[60:63], a[140:143]
    v_mfma_f32_16x16x32_bf16 a[176:179], v[24:27], v[60:63], a[176:179]
    s_mul_i32 s16, s22, 5120
    s_mul_i32 s18, s22, 9216
    s_cmp_lt_u32 s22, 32
    s_cselect_b32 s16, s16, 0x7f000000
    s_cselect_b32 s18, s18, 0x7f000000
    s_add_u32 s17, s16, 4096
    s_add_u32 s19, s18, 4096
    s_add_u32 s20, s18, 8192
    s_add_u32 s22, s22, 1
    buffer_load_dwordx4 v[8:11], v5, s[48:51], s16 offen offset:0
    buffer_load_dwordx4 v[12:15], v5, s[48:51], s16 offen offset:1024
    buffer_load_dwordx4 v[16:19], v5, s[48:51], s16 offen offset:2048
    buffer_load_dwordx4 v[20:23], v5, s[48:51], s16 offen offset:3072
    buffer_load_dwordx4 v[24:27], v5, s[48:51], s17 offen offset:0
    buffer_load_dwordx4 v[28:31], v4, s[44:47], s18 offen offset:0
    buffer_load_dwordx4 v[32:35], v4, s[44:47], s18 offen offset:1024
    buffer_load_dwordx4 v[36:39], v4, s[44:47], s18 offen offset:2048
    buffer_load_dwordx4 v[40:43], v4, s[44:47], s18 offen offset:3072
    buffer_load_dwordx4 v[44:47], v4, s[44:47], s19 offen offset:0
    buffer_load_dwordx4 v[48:51], v4, s[44:47], s19 offen offset:1024
    buffer_load_dwordx4 v[52:55], v4, s[44:47], s19 offen offset:2048
    buffer_load_dwordx4 v[56:59], v4, s[44:47], s19 offen offset:3072
    buffer_load_dwordx4 v[60:63], v4, s[44:47], s20 offen offset:0
    s_waitcnt vmcnt(42)
    v_mfma_f32_16x16x32_bf16 a[0:3], v[64:67], v[84:87], a[0:3]
    v_mfma_f32_16x16x32_bf16 a[36:39], v[68:71], v[84:87], a[36:39]
    v_mfma_f32_16x16x32_bf16 a[72:75], v[72:75], v[84:87], a[72:75]
    v_mfma_f32_16x16x32_bf16 a[108:111], v[76:79], v[84:87], a[108:111]
    v_mfma_f32_16x16x32_bf16 a[144:147], v[80:83], v[84:87], a[144:147]
    v_mfma_f32_16x16x32_bf16 a[4:7], v[64:67], v[88:91], a[4:7]
    v_mfma_f32_16x16x32_bf16 a[40:43], v[68:71], v[88:91], a[40:43]
    v_mfma_f32_16x16x32_bf16 a[76:79], v[72:75], v[88:91], a[76:79]
    v_mfma_f32_16x16x32_bf16 a[112:115], v[76:79], v[88:91], a[112:115]
    v_mfma_f32_16x16x32_bf16 a[148:151], v[80:83], v[88:91], a[148:151]
    v_mfma_f32_16x16x32_bf16 a[8:11], v[64:67], v[92:95], a[8:11]
    v_mfma_f32_16x16x32_bf16 a[44:47], v[68:71], v[92:95], a[44:47]
    v_mfma_f32_16x16x32_bf16 a[80:83], v[72:75], v[92:95], a[80:83]
    v_mfma_f32_16x16x32_bf16 a[116:119], v[76:79], v[92:95], a[116:119]
    v_mfma_f32_16x16x32_bf16 a[152:155], v[80:83], v[92:95], a[152:155]
    v_mfma_f32_16x16x32_bf16 a[12:15], v[64:67], v[96:99], a[12:15]
    v_mfma_f32_16x16x32_bf16 a[48:51], v[68:71], v[96:99], a[48:51]
    v_mfma_f32_16x16x32_bf16 a[84:87], v[72:75], v[96:99], a[84:87]
    v_mfma_f32_16x16x32_bf16 a[120:123], v[76:79], v[96:99], a[120:123]
    v_mfma_f32_16x16x32_bf16 a[156:159], v[80:83], v[96:99], a[156:159]
    v_mfma_f32_16x16x32_bf16 a[16:19], v[64:67], v[100:103], a[16:19]
    v_mfma_f32_16x16x32_bf16 a[52:55], v[68:71], v[100:103], a[52:55]
    v_mfma_f32_16x16x32_bf16 a[88:91], v[72:75], v[100:103], a[88:91]
    v_mfma_f32_16x16x32_bf16 a[124:127], v[76:79], v[100:103], a[124:127]
    v_mfma_f32_16x16x32_bf16 a[160:163], v[80:83], v[100:103], a[160:163]
    v_mfma_f32_16x16x32_bf16 a[20:23], v[64:67], v[104:107], a[20:23]
    v_mfma_f32_16x16x32_bf16 a[56:59], v[68:71], v[104:107], a[56:59]
    v_mfma_f32_16x16x32_bf16 a[92:95], v[72:75], v[104:107], a[92:95]
    v_mfma_f32_16x16x32_bf16 a[128:131], v[76:79], v[104:107], a[128:131]
    v_mfma_f32_16x16x32_bf16 a[164:167], v[80:83], v[104:107], a[164:167]
    v_mfma_f32_16x16x32_bf16 a[24:27], v[64:67], v[108:111], a[24:27]
    v_mfma_f32_16x16x32_bf16 a[60:63], v[68:71], v[108:111], a[60:63]
    v_mfma_f32_16x16x32_bf16 a[96:99], v[72:75], v[108:111], a[96:99]
    v_mfma_f32_16x16x32_bf16 a[132:135], v[76:79], v[108:111], a[132:135]
    v_mfma_f32_16x16x32_bf16 a[168:171], v[80:83], v[108:111], a[168:171]
    v_mfma_f32_16x16x32_bf16 a[28:31], v[64:67], v[112:115], a[28:31]
    v_mfma_f32_16x16x32_bf16 a[64:67], v[68:71], v[112:115], a[64:67]
    v_mfma_f32_16x16x32_bf16 a[100:103], v[72:75], v[112:115], a[100:103]
    v_mfma_f32_16x16x32_bf16 a[136:139], v[76:79], v[112:115], a[136:139]
    v_mfma_f32_16x16x32_bf16 a[172:175], v[80:83], v[112:115], a[172:175]
    v_mfma_f32_16x16x32_bf16 a[32:35], v[64:67], v[116:119], a[32:35]
    v_mfma_f32_16x16x32_bf16 a[68:71], v[68:71], v[116:119], a[68:71]
    v_mfma_f32_16x16x32_bf16 a[104:107], v[72:75], v[116:119], a[104:107]
    v_mfma_f32_16x16x32_bf16 a[140:143], v[76:79], v[116:119], a[140:143]
    v_mfma_f32_16x16x32_bf16 a[176:179], v[80:83], v[116:119], a[176:179]
    s_mul_i32 s16, s22, 5120
    s_mul_i32 s18, s22, 9216
    s_cmp_lt_u32 s22, 32
    s_cselect_b32 s16, s16, 0x7f000000
    s_cselect_b32 s18, s18, 0x7f000000
    s_add_u32 s17, s16, 4096
    s_add_u32 s19, s18, 4096
    s_add_u32 s20, s18, 8192
    s_add_u32 s22, s22, 1
    buffer_load_dwordx4 v[64:67], v5, s[48:51], s16 offen offset:0
    buffer_load_dwordx4 v[68:71], v5, s[48:51], s16 offen offset:1024
    buffer_load_dwordx4 v[72:75], v5, s[48:51], s16 offen offset:2048
    buffer_load_dwordx4 v[76:79], v5, s[48:51], s16 offen offset:3072
    buffer_load_dwordx4 v[80:83], v5, s[48:51], s17 offen offset:0
    buffer_load_dwordx4 v[84:87], v4, s[44:47], s18 offen offset:0
    buffer_load_dwordx4 v[88:91], v4, s[44:47], s18 offen offset:1024
    buffer_load_dwordx4 v[92:95], v4, s[44:47], s18 offen offset:2048
    buffer_load_dwordx4 v[96:99], v4, s[44:47], s18 offen offset:3072
    buffer_load_dwordx4 v[100:103], v4, s[44:47], s19 offen offset:0
    buffer_load_dwordx4 v[104:107], v4, s[44:47], s19 offen offset:1024
    buffer_load_dwordx4 v[108:111], v4, s[44:47], s19 offen offset:2048
    buffer_load_dwordx4 v[112:115], v4, s[44:47], s19 offen offset:3072
    buffer_load_dwordx4 v[116:119], v4, s[44:47], s20 offen offset:0
    s_waitcnt vmcnt(42)
    v_mfma_f32_16x16x32_bf16 a[0:3], v[120:123], v[140:143], a[0:3]
    v_mfma_f32_16x16x32_bf16 a[36:39], v[124:127], v[140:143], a[36:39]
    v_mfma_f32_16x16x32_bf16 a[72:75], v[128:131], v[140:143], a[72:75]
    v_mfma_f32_16x16x32_bf16 a[108:111], v[132:135], v[140:143], a[108:111]
    v_mfma_f32_16x16x32_bf16 a[144:147], v[136:139], v[140:143], a[144:147]
    v_mfma_f32_16x16x32_bf16 a[4:7], v[120:123], v[144:147], a[4:7]
    v_mfma_f32_16x16x32_bf16 a[40:43], v[124:127], v[144:147], a[40:43]
    v_mfma_f32_16x16x32_bf16 a[76:79], v[128:131], v[144:147], a[76:79]
    v_mfma_f32_16x16x32_bf16 a[112:115], v[132:135], v[144:147], a[112:115]
    v_mfma_f32_16x16x32_bf16 a[148:151], v[136:139], v[144:147], a[148:151]
    v_mfma_f32_16x16x32_bf16 a[8:11], v[120:123], v[148:151], a[8:11]
    v_mfma_f32_16x16x32_bf16 a[44:47], v[124:127], v[148:151], a[44:47]
    v_mfma_f32_16x16x32_bf16 a[80:83], v[128:131], v[148:151], a[80:83]
    v_mfma_f32_16x16x32_bf16 a[116:119], v[132:135], v[148:151], a[116:119]
    v_mfma_f32_16x16x32_bf16 a[152:155], v[136:139], v[148:151], a[152:155]
    v_mfma_f32_16x16x32_bf16 a[12:15], v[120:123], v[152:155], a[12:15]
    v_mfma_f32_16x16x32_bf16 a[48:51], v[124:127], v[152:155], a[48:51]
    v_mfma_f32_16x16x32_bf16 a[84:87], v[128:131], v[152:155], a[84:87]
    v_mfma_f32_16x16x32_bf16 a[120:123], v[132:135], v[152:155], a[120:123]
    v_mfma_f32_16x16x32_bf16 a[156:159], v[136:139], v[152:155], a[156:159]
    v_mfma_f32_16x16x32_bf16 a[16:19], v[120:123], v[156:159], a[16:19]
    v_mfma_f32_16x16x32_bf16 a[52:55], v[124:127], v[156:159], a[52:55]
    v_mfma_f32_16x16x32_bf16 a[88:91], v[128:131], v[156:159], a[88:91]
    v_mfma_f32_16x16x32_bf16 a[124:127], v[132:135], v[156:159], a[124:127]
    v_mfma_f32_16x16x32_bf16 a[160:163], v[136:139], v[156:159], a[160:163]
    v_mfma_f32_16x16x32_bf16 a[20:23], v[120:123], v[160:163], a[20:23]
    v_mfma_f32_16x16x32_bf16 a[56:59], v[124:127], v[160:163], a[56:59]
    v_mfma_f32_16x16x32_bf16 a[92:95], v[128:131], v[160:163], a[92:95]
    v_mfma_f32_16x16x32_bf16 a[128:131], v[132:135], v[160:163], a[128:131]
    v_mfma_f32_16x16x32_bf16 a[164:167], v[136:139], v[160:163], a[164:167]
    v_mfma_f32_16x16x32_bf16 a[24:27], v[120:123], v[164:167], a[24:27]
    v_mfma_f32_16x16x32_bf16 a[60:63], v[124:127], v[164:167], a[60:63]
    v_mfma_f32_16x16x32_bf16 a[96:99], v[128:131], v[164:167], a[96:99]
    v_mfma_f32_16x16x32_bf16 a[132:135], v[132:135], v[164:167], a[132:135]
    v_mfma_f32_16x16x32_bf16 a[168:171], v[136:139], v[164:167], a[168:171]
    v_mfma_f32_16x16x32_bf16 a[28:31], v[120:123], v[168:171], a[28:31]
    v_mfma_f32_16x16x32_bf16 a[64:67], v[124:127], v[168:171], a[64:67]
    v_mfma_f32_16x16x32_bf16 a[100:103], v[128:131], v[168:171], a[100:103]
    v_mfma_f32_16x16x32_bf16 a[136:139], v[132:135], v[168:171], a[136:139]
    v_mfma_f32_16x16x32_bf16 a[172:175], v[136:139], v[168:171], a[172:175]
    v_mfma_f32_16x16x32_bf16 a[32:35], v[120:123], v[172:175], a[32:35]
    v_mfma_f32_16x16x32_bf16 a[68:71], v[124:127], v[172:175], a[68:71]
    v_mfma_f32_16x16x32_bf16 a[104:107], v[128:131], v[172:175], a[104:107]
    v_mfma_f32_16x16x32_bf16 a[140:143], v[132:135], v[172:175], a[140:143]
    v_mfma_f32_16x16x32_bf16 a[176:179], v[136:139], v[172:175], a[176:179]
    s_mul_i32 s16, s22, 5120
    s_mul_i32 s18, s22, 9216
    s_cmp_lt_u32 s22, 32
    s_cselect_b32 s16, s16, 0x7f000000
    s_cselect_b32 s18, s18, 0x7f000000
    s_add_u32 s17, s16, 4096
    s_add_u32 s19, s18, 4096
    s_add_u32 s20, s18, 8192
    s_add_u32 s22, s22, 1
    buffer_load_dwordx4 v[120:123], v5, s[48:51], s16 offen offset:0
    buffer_load_dwordx4 v[124:127], v5, s[48:51], s16 offen offset:1024
    buffer_load_dwordx4 v[128:131], v5, s[48:51], s16 offen offset:2048
    buffer_load_dwordx4 v[132:135], v5, s[48:51], s16 offen offset:3072
    buffer_load_dwordx4 v[136:139], v5, s[48:51], s17 offen offset:0
    buffer_load_dwordx4 v[140:143], v4, s[44:47], s18 offen offset:0
    buffer_load_dwordx4 v[144:147], v4, s[44:47], s18 offen offset:1024
    buffer_load_dwordx4 v[148:151], v4, s[44:47], s18 offen offset:2048
    buffer_load_dwordx4 v[152:155], v4, s[44:47], s18 offen offset:3072
    buffer_load_dwordx4 v[156:159], v4, s[44:47], s19 offen offset:0
    buffer_load_dwordx4 v[160:163], v4, s[44:47], s19 offen offset:1024
    buffer_load_dwordx4 v[164:167], v4, s[44:47], s19 offen offset:2048
    buffer_load_dwordx4 v[168:171], v4, s[44:47], s19 offen offset:3072
    buffer_load_dwordx4 v[172:175], v4, s[44:47], s20 offen offset:0
    s_waitcnt vmcnt(42)
    v_mfma_f32_16x16x32_bf16 a[0:3], v[176:179], v[196:199], a[0:3]
    v_mfma_f32_16x16x32_bf16 a[36:39], v[180:183], v[196:199], a[36:39]
    v_mfma_f32_16x16x32_bf16 a[72:75], v[184:187], v[196:199], a[72:75]
    v_mfma_f32_16x16x32_bf16 a[108:111], v[188:191], v[196:199], a[108:111]
    v_mfma_f32_16x16x32_bf16 a[144:147], v[192:195], v[196:199], a[144:147]
    v_mfma_f32_16x16x32_bf16 a[4:7], v[176:179], v[200:203], a[4:7]
    v_mfma_f32_16x16x32_bf16 a[40:43], v[180:183], v[200:203], a[40:43]
    v_mfma_f32_16x16x32_bf16 a[76:79], v[184:187], v[200:203], a[76:79]
    v_mfma_f32_16x16x32_bf16 a[112:115], v[188:191], v[200:203], a[112:115]
    v_mfma_f32_16x16x32_bf16 a[148:151], v[192:195], v[200:203], a[148:151]
    v_mfma_f32_16x16x32_bf16 a[8:11], v[176:179], v[204:207], a[8:11]
    v_mfma_f32_16x16x32_bf16 a[44:47], v[180:183], v[204:207], a[44:47]
    v_mfma_f32_16x16x32_bf16 a[80:83], v[184:187], v[204:207], a[80:83]
    v_mfma_f32_16x16x32_bf16 a[116:119], v[188:191], v[204:207], a[116:119]
    v_mfma_f32_16x16x32_bf16 a[152:155], v[192:195], v[204:207], a[152:155]
    v_mfma_f32_16x16x32_bf16 a[12:15], v[176:179], v[208:211], a[12:15]
    v_mfma_f32_16x16x32_bf16 a[48:51], v[180:183], v[208:211], a[48:51]
    v_mfma_f32_16x16x32_bf16 a[84:87], v[184:187], v[208:211], a[84:87]
    v_mfma_f32_16x16x32_bf16 a[120:123], v[188:191], v[208:211], a[120:123]
    v_mfma_f32_16x16x32_bf16 a[156:159], v[192:195], v[208:211], a[156:159]
    v_mfma_f32_16x16x32_bf16 a[16:19], v[176:179], v[212:215], a[16:19]
    v_mfma_f32_16x16x32_bf16 a[52:55], v[180:183], v[212:215], a[52:55]
    v_mfma_f32_16x16x32_bf16 a[88:91], v[184:187], v[212:215], a[88:91]
    v_mfma_f32_16x16x32_bf16 a[124:127], v[188:191], v[212:215], a[124:127]
    v_mfma_f32_16x16x32_bf16 a[160:163], v[192:195], v[212:215], a[160:163]
    v_mfma_f32_16x16x32_bf16 a[20:23], v[176:179], v[216:219], a[20:23]
    v_mfma_f32_16x16x32_bf16 a[56:59], v[180:183], v[216:219], a[56:59]
    v_mfma_f32_16x16x32_bf16 a[92:95], v[184:187], v[216:219], a[92:95]
    v_mfma_f32_16x16x32_bf16 a[128:131], v[188:191], v[216:219], a[128:131]
    v_mfma_f32_16x16x32_bf16 a[164:167], v[192:195], v[216:219], a[164:167]
    v_mfma_f32_16x16x32_bf16 a[24:27], v[176:179], v[220:223], a[24:27]
    v_mfma_f32_16x16x32_bf16 a[60:63], v[180:183], v[220:223], a[60:63]
    v_mfma_f32_16x16x32_bf16 a[96:99], v[184:187], v[220:223], a[96:99]
    v_mfma_f32_16x16x32_bf16 a[132:135], v[188:191], v[220:223], a[132:135]
    v_mfma_f32_16x16x32_bf16 a[168:171], v[192:195], v[220:223], a[168:171]
    v_mfma_f32_16x16x32_bf16 a[28:31], v[176:179], v[224:227], a[28:31]
    v_mfma_f32_16x16x32_bf16 a[64:67], v[180:183], v[224:227], a[64:67]
    v_mfma_f32_16x16x32_bf16 a[100:103], v[184:187], v[224:227], a[100:103]
    v_mfma_f32_16x16x32_bf16 a[136:139], v[188:191], v[224:227], a[136:139]
    v_mfma_f32_16x16x32_bf16 a[172:175], v[192:195], v[224:227], a[172:175]
    v_mfma_f32_16x16x32_bf16 a[32:35], v[176:179], v[228:231], a[32:35]
    v_mfma_f32_16x16x32_bf16 a[68:71], v[180:183], v[228:231], a[68:71]
    v_mfma_f32_16x16x32_bf16 a[104:107], v[184:187], v[228:231], a[104:107]
    v_mfma_f32_16x16x32_bf16 a[140:143], v[188:191], v[228:231], a[140:143]
    v_mfma_f32_16x16x32_bf16 a[176:179], v[192:195], v[228:231], a[176:179]
    s_cmp_lt_u32 s22, 35
    s_cbranch_scc1 L_k2_loop
    s_waitcnt vmcnt(0)
    s_mul_i32 s10, s3, 24576
    v_add_u32 v4, s10, v3
    s_mul_i32 s10, s3, 6144
    v_add_u32 v5, s10, v3
    v_add_u32 v6, 49152, v5
    s_mul_i32 s10, s5, 144
    v_and_b32 v7, 15, v2
    v_add_u32 v7, s10, v7
    s_movk_i32 s11, 2560
    v_mul_lo_u32 v7, v7, s11
    v_lshrrev_b32 v1, 4, v2
    v_lshl_add_u32 v7, v1, 3, v7
    s_mul_i32 s10, s4, 1280
    s_mul_i32 s11, s6, 160
    s_add_u32 s10, s10, s11
    v_add_u32 v7, s10, v7
    s_mul_i32 s12, s3, 6
    s_nop 7
    ds_write_b128 v4, a[0:3] offset:0
    ds_write_b128 v4, a[4:7] offset:1024
    ds_write_b128 v4, a[8:11] offset:2048
    ds_write_b128 v4, a[12:15] offset:3072
    ds_write_b128 v4, a[16:19] offset:4096
    ds_write_b128 v4, a[20:23] offset:5120
    ds_write_b128 v4, a[24:27] offset:6144
    ds_write_b128 v4, a[28:31] offset:7168
    ds_write_b128 v4, a[32:35] offset:8192
    ds_write_b128 v4, a[36:39] offset:9216
    ds_write_b128 v4, a[40:43] offset:10240
    ds_write_b128 v4, a[44:47] offset:11264
    ds_write_b128 v4, a[48:51] offset:12288
    ds_write_b128 v4, a[52:55] offset:13312
    ds_write_b128 v4, a[56:59] offset:14336
    ds_write_b128 v4, a[60:63] offset:15360
    ds_write_b128 v4, a[64:67] offset:16384
    ds_write_b128 v4, a[68:71] offset:17408
    ds_write_b128 v4, a[72:75] offset:18432
    ds_write_b128 v4, a[76:79] offset:19456
    ds_write_b128 v4, a[80:83] offset:20480
    ds_write_b128 v4, a[84:87] offset:21504
    ds_write_b128 v4, a[88:91] offset:22528
    ds_write_b128 v4, a[92:95] offset:23552
    s_waitcnt lgkmcnt(0)
    s_barrier
    ds_read_b128 v[8:11], v5 offset:0
    ds_read_b128 v[12:15], v5 offset:24576
    ds_read_b128 v[16:19], v6 offset:0
    ds_read_b128 v[20:23], v6 offset:24576
    ds_read_b128 v[24:27], v5 offset:1024
    ds_read_b128 v[28:31], v5 offset:25600
    ds_read_b128 v[32:35], v6 offset:1024
    ds_read_b128 v[36:39], v6 offset:25600
    ds_read_b128 v[40:43], v5 offset:2048
    ds_read_b128 v[44:47], v5 offset:26624
    ds_read_b128 v[48:51], v6 offset:2048
    ds_read_b128 v[52:55], v6 offset:26624
    s_waitcnt lgkmcnt(0)
    ds_read_b128 v[56:59], v5 offset:3072
    ds_read_b128 v[60:63], v5 offset:27648
    ds_read_b128 v[64:67], v6 offset:3072
    ds_read_b128 v[68:71], v6 offset:27648
    ds_read_b128 v[72:75], v5 offset:4096
    ds_read_b128 v[76:79], v5 offset:28672
    ds_read_b128 v[80:83], v6 offset:4096
    ds_read_b128 v[84:87], v6 offset:28672
    ds_read_b128 v[88:91], v5 offset:5120
    ds_read_b128 v[92:95], v5 offset:29696
    ds_read_b128 v[96:99], v6 offset:5120
    ds_read_b128 v[100:103], v6 offset:29696
    s_waitcnt lgkmcnt(0)
    v_add_f32 v8, v8, v12
    v_add_f32 v16, v16, v20
    v_add_f32 v9, v9, v13
    v_add_f32 v17, v17, v21
    v_add_f32 v10, v10, v14
    v_add_f32 v18, v18, v22
    v_add_f32 v11, v11, v15
    v_add_f32 v19, v19, v23
    v_add_f32 v8, v8, v16
    v_add_f32 v9, v9, v17
    v_add_f32 v10, v10, v18
    v_add_f32 v11, v11, v19
    v_cvt_pk_bf16_f32 v12, v8, v9
    v_cvt_pk_bf16_f32 v13, v10, v11
    s_add_u32 s13, s12, 0
    s_mul_i32 s14, s13, 57
    s_lshr_b32 s14, s14, 9
    s_mul_i32 s15, s14, 9
    s_sub_u32 s15, s13, s15
    s_mul_i32 s15, s15, 40960
    s_lshl_b32 s14, s14, 5
    s_add_u32 s14, s14, s15
    s_cmp_lt_u32 s13, 45
    s_cselect_b32 s14, s14, 0x40000000
    buffer_store_dwordx2 v[12:13], v7, s[52:55], s14 offen sc0 sc1
    v_add_f32 v24, v24, v28
    v_add_f32 v32, v32, v36
    v_add_f32 v25, v25, v29
    v_add_f32 v33, v33, v37
    v_add_f32 v26, v26, v30
    v_add_f32 v34, v34, v38
    v_add_f32 v27, v27, v31
    v_add_f32 v35, v35, v39
    v_add_f32 v24, v24, v32
    v_add_f32 v25, v25, v33
    v_add_f32 v26, v26, v34
    v_add_f32 v27, v27, v35
    v_cvt_pk_bf16_f32 v28, v24, v25
    v_cvt_pk_bf16_f32 v29, v26, v27
    s_add_u32 s13, s12, 1
    s_mul_i32 s14, s13, 57
    s_lshr_b32 s14, s14, 9
    s_mul_i32 s15, s14, 9
    s_sub_u32 s15, s13, s15
    s_mul_i32 s15, s15, 40960
    s_lshl_b32 s14, s14, 5
    s_add_u32 s14, s14, s15
    s_cmp_lt_u32 s13, 45
    s_cselect_b32 s14, s14, 0x40000000
    buffer_store_dwordx2 v[28:29], v7, s[52:55], s14 offen sc0 sc1
    v_add_f32 v40, v40, v44
    v_add_f32 v48, v48, v52
    v_add_f32 v41, v41, v45
    v_add_f32 v49, v49, v53
    v_add_f32 v42, v42, v46
    v_add_f32 v50, v50, v54
    v_add_f32 v43, v43, v47
    v_add_f32 v51, v51, v55
    v_add_f32 v40, v40, v48
    v_add_f32 v41, v41, v49
    v_add_f32 v42, v42, v50
    v_add_f32 v43, v43, v51
    v_cvt_pk_bf16_f32 v44, v40, v41
    v_cvt_pk_bf16_f32 v45, v42, v43
    s_add_u32 s13, s12, 2
    s_mul_i32 s14, s13, 57
    s_lshr_b32 s14, s14, 9
    s_mul_i32 s15, s14, 9
    s_sub_u32 s15, s13, s15
    s_mul_i32 s15, s15, 40960
    s_lshl_b32 s14, s14, 5
    s_add_u32 s14, s14, s15
    s_cmp_lt_u32 s13, 45
    s_cselect_b32 s14, s14, 0x40000000
    buffer_store_dwordx2 v[44:45], v7, s[52:55], s14 offen sc0 sc1
    v_add_f32 v56, v56, v60
    v_add_f32 v64, v64, v68
    v_add_f32 v57, v57, v61
    v_add_f32 v65, v65, v69
    v_add_f32 v58, v58, v62
    v_add_f32 v66, v66, v70
    v_add_f32 v59, v59, v63
    v_add_f32 v67, v67, v71
    v_add_f32 v56, v56, v64
    v_add_f32 v57, v57, v65
    v_add_f32 v58, v58, v66
    v_add_f32 v59, v59, v67
    v_cvt_pk_bf16_f32 v60, v56, v57
    v_cvt_pk_bf16_f32 v61, v58, v59
    s_add_u32 s13, s12, 3
    s_mul_i32 s14, s13, 57
    s_lshr_b32 s14, s14, 9
    s_mul_i32 s15, s14, 9
    s_sub_u32 s15, s13, s15
    s_mul_i32 s15, s15, 40960
    s_lshl_b32 s14, s14, 5
    s_add_u32 s14, s14, s15
    s_cmp_lt_u32 s13, 45
    s_cselect_b32 s14, s14, 0x40000000
    buffer_store_dwordx2 v[60:61], v7, s[52:55], s14 offen sc0 sc1
    v_add_f32 v72, v72, v76
    v_add_f32 v80, v80, v84
    v_add_f32 v73, v73, v77
    v_add_f32 v81, v81, v85
    v_add_f32 v74, v74, v78
    v_add_f32 v82, v82, v86
    v_add_f32 v75, v75, v79
    v_add_f32 v83, v83, v87
    v_add_f32 v72, v72, v80
    v_add_f32 v73, v73, v81
    v_add_f32 v74, v74, v82
    v_add_f32 v75, v75, v83
    v_cvt_pk_bf16_f32 v76, v72, v73
    v_cvt_pk_bf16_f32 v77, v74, v75
    s_add_u32 s13, s12, 4
    s_mul_i32 s14, s13, 57
    s_lshr_b32 s14, s14, 9
    s_mul_i32 s15, s14, 9
    s_sub_u32 s15, s13, s15
    s_mul_i32 s15, s15, 40960
    s_lshl_b32 s14, s14, 5
    s_add_u32 s14, s14, s15
    s_cmp_lt_u32 s13, 45
    s_cselect_b32 s14, s14, 0x40000000
    buffer_store_dwordx2 v[76:77], v7, s[52:55], s14 offen sc0 sc1
    v_add_f32 v88, v88, v92
    v_add_f32 v96, v96, v100
    v_add_f32 v89, v89, v93
    v_add_f32 v97, v97, v101
    v_add_f32 v90, v90, v94
    v_add_f32 v98, v98, v102
    v_add_f32 v91, v91, v95
    v_add_f32 v99, v99, v103
    v_add_f32 v88, v88, v96
    v_add_f32 v89, v89, v97
    v_add_f32 v90, v90, v98
    v_add_f32 v91, v91, v99
    v_cvt_pk_bf16_f32 v92, v88, v89
    v_cvt_pk_bf16_f32 v93, v90, v91
    s_add_u32 s13, s12, 5
    s_mul_i32 s14, s13, 57
    s_lshr_b32 s14, s14, 9
    s_mul_i32 s15, s14, 9
    s_sub_u32 s15, s13, s15
    s_mul_i32 s15, s15, 40960
    s_lshl_b32 s14, s14, 5
    s_add_u32 s14, s14, s15
    s_cmp_lt_u32 s13, 45
    s_cselect_b32 s14, s14, 0x40000000
    buffer_store_dwordx2 v[92:93], v7, s[52:55], s14 offen sc0 sc1
    s_barrier
    ds_write_b128 v4, a[96:99] offset:0
    ds_write_b128 v4, a[100:103] offset:1024
    ds_write_b128 v4, a[104:107] offset:2048
    ds_write_b128 v4, a[108:111] offset:3072
    ds_write_b128 v4, a[112:115] offset:4096
    ds_write_b128 v4, a[116:119] offset:5120
    ds_write_b128 v4, a[120:123] offset:6144
    ds_write_b128 v4, a[124:127] offset:7168
    ds_write_b128 v4, a[128:131] offset:8192
    ds_write_b128 v4, a[132:135] offset:9216
    ds_write_b128 v4, a[136:139] offset:10240
    ds_write_b128 v4, a[140:143] offset:11264
    ds_write_b128 v4, a[144:147] offset:12288
    ds_write_b128 v4, a[148:151] offset:13312
    ds_write_b128 v4, a[152:155] offset:14336
    ds_write_b128 v4, a[156:159] offset:15360
    ds_write_b128 v4, a[160:163] offset:16384
    ds_write_b128 v4, a[164:167] offset:17408
    ds_write_b128 v4, a[168:171] offset:18432
    ds_write_b128 v4, a[172:175] offset:19456
    ds_write_b128 v4, a[176:179] offset:20480
    s_waitcnt lgkmcnt(0)
    s_barrier
    ds_read_b128 v[8:11], v5 offset:0
    ds_read_b128 v[12:15], v5 offset:24576
    ds_read_b128 v[16:19], v6 offset:0
    ds_read_b128 v[20:23], v6 offset:24576
    ds_read_b128 v[24:27], v5 offset:1024
    ds_read_b128 v[28:31], v5 offset:25600
    ds_read_b128 v[32:35], v6 offset:1024
    ds_read_b128 v[36:39], v6 offset:25600
    ds_read_b128 v[40:43], v5 offset:2048
    ds_read_b128 v[44:47], v5 offset:26624
    ds_read_b128 v[48:51], v6 offset:2048
    ds_read_b128 v[52:55], v6 offset:26624
    s_waitcnt lgkmcnt(0)
    ds_read_b128 v[56:59], v5 offset:3072
    ds_read_b128 v[60:63], v5 offset:27648
    ds_read_b128 v[64:67], v6 offset:3072
    ds_read_b128 v[68:71], v6 offset:27648
    ds_read_b128 v[72:75], v5 offset:4096
    ds_read_b128 v[76:79], v5 offset:28672
    ds_read_b128 v[80:83], v6 offset:4096
    ds_read_b128 v[84:87], v6 offset:28672
    ds_read_b128 v[88:91], v5 offset:5120
    ds_read_b128 v[92:95], v5 offset:29696
    ds_read_b128 v[96:99], v6 offset:5120
    ds_read_b128 v[100:103], v6 offset:29696
    s_waitcnt lgkmcnt(0)
    v_add_f32 v8, v8, v12
    v_add_f32 v16, v16, v20
    v_add_f32 v9, v9, v13
    v_add_f32 v17, v17, v21
    v_add_f32 v10, v10, v14
    v_add_f32 v18, v18, v22
    v_add_f32 v11, v11, v15
    v_add_f32 v19, v19, v23
    v_add_f32 v8, v8, v16
    v_add_f32 v9, v9, v17
    v_add_f32 v10, v10, v18
    v_add_f32 v11, v11, v19
    v_cvt_pk_bf16_f32 v12, v8, v9
    v_cvt_pk_bf16_f32 v13, v10, v11
    s_add_u32 s13, s12, 24
    s_mul_i32 s14, s13, 57
    s_lshr_b32 s14, s14, 9
    s_mul_i32 s15, s14, 9
    s_sub_u32 s15, s13, s15
    s_mul_i32 s15, s15, 40960
    s_lshl_b32 s14, s14, 5
    s_add_u32 s14, s14, s15
    s_cmp_lt_u32 s13, 45
    s_cselect_b32 s14, s14, 0x40000000
    buffer_store_dwordx2 v[12:13], v7, s[52:55], s14 offen sc0 sc1
    v_add_f32 v24, v24, v28
    v_add_f32 v32, v32, v36
    v_add_f32 v25, v25, v29
    v_add_f32 v33, v33, v37
    v_add_f32 v26, v26, v30
    v_add_f32 v34, v34, v38
    v_add_f32 v27, v27, v31
    v_add_f32 v35, v35, v39
    v_add_f32 v24, v24, v32
    v_add_f32 v25, v25, v33
    v_add_f32 v26, v26, v34
    v_add_f32 v27, v27, v35
    v_cvt_pk_bf16_f32 v28, v24, v25
    v_cvt_pk_bf16_f32 v29, v26, v27
    s_add_u32 s13, s12, 25
    s_mul_i32 s14, s13, 57
    s_lshr_b32 s14, s14, 9
    s_mul_i32 s15, s14, 9
    s_sub_u32 s15, s13, s15
    s_mul_i32 s15, s15, 40960
    s_lshl_b32 s14, s14, 5
    s_add_u32 s14, s14, s15
    s_cmp_lt_u32 s13, 45
    s_cselect_b32 s14, s14, 0x40000000
    buffer_store_dwordx2 v[28:29], v7, s[52:55], s14 offen sc0 sc1
    v_add_f32 v40, v40, v44
    v_add_f32 v48, v48, v52
    v_add_f32 v41, v41, v45
    v_add_f32 v49, v49, v53
    v_add_f32 v42, v42, v46
    v_add_f32 v50, v50, v54
    v_add_f32 v43, v43, v47
    v_add_f32 v51, v51, v55
    v_add_f32 v40, v40, v48
    v_add_f32 v41, v41, v49
    v_add_f32 v42, v42, v50
    v_add_f32 v43, v43, v51
    v_cvt_pk_bf16_f32 v44, v40, v41
    v_cvt_pk_bf16_f32 v45, v42, v43
    s_add_u32 s13, s12, 26
    s_mul_i32 s14, s13, 57
    s_lshr_b32 s14, s14, 9
    s_mul_i32 s15, s14, 9
    s_sub_u32 s15, s13, s15
    s_mul_i32 s15, s15, 40960
    s_lshl_b32 s14, s14, 5
    s_add_u32 s14, s14, s15
    s_cmp_lt_u32 s13, 45
    s_cselect_b32 s14, s14, 0x40000000
    buffer_store_dwordx2 v[44:45], v7, s[52:55], s14 offen sc0 sc1
    v_add_f32 v56, v56, v60
    v_add_f32 v64, v64, v68
    v_add_f32 v57, v57, v61
    v_add_f32 v65, v65, v69
    v_add_f32 v58, v58, v62
    v_add_f32 v66, v66, v70
    v_add_f32 v59, v59, v63
    v_add_f32 v67, v67, v71
    v_add_f32 v56, v56, v64
    v_add_f32 v57, v57, v65
    v_add_f32 v58, v58, v66
    v_add_f32 v59, v59, v67
    v_cvt_pk_bf16_f32 v60, v56, v57
    v_cvt_pk_bf16_f32 v61, v58, v59
    s_add_u32 s13, s12, 27
    s_mul_i32 s14, s13, 57
    s_lshr_b32 s14, s14, 9
    s_mul_i32 s15, s14, 9
    s_sub_u32 s15, s13, s15
    s_mul_i32 s15, s15, 40960
    s_lshl_b32 s14, s14, 5
    s_add_u32 s14, s14, s15
    s_cmp_lt_u32 s13, 45
    s_cselect_b32 s14, s14, 0x40000000
    buffer_store_dwordx2 v[60:61], v7, s[52:55], s14 offen sc0 sc1
    v_add_f32 v72, v72, v76
    v_add_f32 v80, v80, v84
    v_add_f32 v73, v73, v77
    v_add_f32 v81, v81, v85
    v_add_f32 v74, v74, v78
    v_add_f32 v82, v82, v86
    v_add_f32 v75, v75, v79
    v_add_f32 v83, v83, v87
    v_add_f32 v72, v72, v80
    v_add_f32 v73, v73, v81
    v_add_f32 v74, v74, v82
    v_add_f32 v75, v75, v83
    v_cvt_pk_bf16_f32 v76, v72, v73
    v_cvt_pk_bf16_f32 v77, v74, v75
    s_add_u32 s13, s12, 28
    s_mul_i32 s14, s13, 57
    s_lshr_b32 s14, s14, 9
    s_mul_i32 s15, s14, 9
    s_sub_u32 s15, s13, s15
    s_mul_i32 s15, s15, 40960
    s_lshl_b32 s14, s14, 5
    s_add_u32 s14, s14, s15
    s_cmp_lt_u32 s13, 45
    s_cselect_b32 s14, s14, 0x40000000
    buffer_store_dwordx2 v[76:77], v7, s[52:55], s14 offen sc0 sc1
    v_add_f32 v88, v88, v92
    v_add_f32 v96, v96, v100
    v_add_f32 v89, v89, v93
    v_add_f32 v97, v97, v101
    v_add_f32 v90, v90, v94
    v_add_f32 v98, v98, v102
    v_add_f32 v91, v91, v95
    v_add_f32 v99, v99, v103
    v_add_f32 v88, v88, v96
    v_add_f32 v89, v89, v97
    v_add_f32 v90, v90, v98
    v_add_f32 v91, v91, v99
    v_cvt_pk_bf16_f32 v92, v88, v89
    v_cvt_pk_bf16_f32 v93, v90, v91
    s_add_u32 s13, s12, 29
    s_mul_i32 s14, s13, 57
    s_lshr_b32 s14, s14, 9
    s_mul_i32 s15, s14, 9
    s_sub_u32 s15, s13, s15
    s_mul_i32 s15, s15, 40960
    s_lshl_b32 s14, s14, 5
    s_add_u32 s14, s14, s15
    s_cmp_lt_u32 s13, 45
    s_cselect_b32 s14, s14, 0x40000000
    buffer_store_dwordx2 v[92:93], v7, s[52:55], s14 offen sc0 sc1
L_k2_end:
    s_endpgm
.section .rodata,"a"
.p2align 6
.amdhsa_kernel concat_heads__gqa_block_cached__gqa_block_cached__near_ridge_kernel
  .amdhsa_next_free_vgpr 256
  .amdhsa_next_free_sgpr 96
  .amdhsa_accum_offset 256
  .amdhsa_group_segment_fixed_size 0
  .amdhsa_kernarg_size 104
  .amdhsa_user_sgpr_count 2
  .amdhsa_user_sgpr_kernarg_segment_ptr 1
  .amdhsa_system_sgpr_workgroup_id_x 1
.end_amdhsa_kernel

.p2align 6
.amdhsa_kernel oproj_kernel
  .amdhsa_next_free_vgpr 436
  .amdhsa_next_free_sgpr 80
  .amdhsa_accum_offset 256
  .amdhsa_group_segment_fixed_size 0
  .amdhsa_kernarg_size 104
  .amdhsa_user_sgpr_count 2
  .amdhsa_user_sgpr_kernarg_segment_ptr 1
  .amdhsa_system_sgpr_workgroup_id_x 1
.end_amdhsa_kernel
```
